```python
import torch

def _softmax(x, axis=-1):
    return torch.softmax(x, dim=axis)
def _gelu(x):
    return torch.nn.functional.gelu(x, approximate="tanh")
def _silu(x):
    return torch.nn.functional.silu(x)
def _sigmoid(x):
    return torch.sigmoid(x)
def _layernorm(x, axis=-1, eps=1e-5):
    m = x.mean(dim=axis, keepdim=True)
    v = x.var(dim=axis, keepdim=True, unbiased=False)
    return (x - m) / torch.sqrt(v + eps)
def _scatter_add(tgt, idx, src, axis=0):
    return tgt.clone().index_add_(axis, idx, src)
def _segment_sum(src, seg, n):
    out = torch.zeros((n,) + src.shape[1:], dtype=src.dtype)
    return out.index_add_(0, seg, src)
def _pad(x, pw):
    flat = tuple(v for pair in reversed(pw) for v in pair)
    return torch.nn.functional.pad(x, flat)

kernel_name = 'parallel_sum__mha_block__dense_activation_mish__prompt'

def setup_inputs():

    _w = (lambda a: (lambda t: t.to(torch.bfloat16) if t.is_floating_point() else t)(torch.as_tensor(a)))
    def _A_setup():
        B, S, D, H = 1, 2048, 512, 32
        return {
            "x": _w((lambda *s: torch.randn(*s, dtype=torch.bfloat16) * 0.05)(B, S, D)),
            "wqkv": _w((lambda *s: torch.randn(*s, dtype=torch.bfloat16) * 0.05)(D, 3 * D)),
            "wo": _w((lambda *s: torch.randn(*s, dtype=torch.bfloat16) * 0.05)(D, D)),
        }
    _A_in = _A_setup()

    def _B_setup():
        B, S, D, F = 1, 2048, 512, 1792
        return {
            "x": _w((lambda *s: torch.randn(*s, dtype=torch.bfloat16) * 0.05)(B, S, D)),
            "w1": _w((lambda *s: torch.randn(*s, dtype=torch.bfloat16) * 0.8)(D, F) * (D ** -0.5)),
            "b1": _w((lambda *s: torch.randn(*s, dtype=torch.bfloat16) * 0.8)(F)),
            "w2": _w((lambda *s: torch.randn(*s, dtype=torch.bfloat16) * 0.2)(F, D) * (F ** -0.5)),
        }
    _B_in = _B_setup()

    return {
        "A_x": _A_in["x"],
        "A_wqkv": _A_in["wqkv"],
        "A_wo": _A_in["wo"],
        "B_x": _B_in["x"],
        "B_w1": _B_in["w1"],
        "B_b1": _B_in["b1"],
        "B_w2": _B_in["w2"],
    }

def reference(A_x, A_wqkv, A_wo, B_x, B_w1, B_b1, B_w2):
    def _A_ref(x, wqkv, wo):
        B, S, D = x.shape
        H = 32
        Dh = D // H
        qkv = (lambda x, *d: x.permute(*d))((x @ wqkv).reshape(B, S, 3, H, Dh), 2, 0, 3, 1, 4)
        q, k, v = qkv[0], qkv[1], qkv[2]
        scores = torch.einsum("bhqd,bhkd->bhqk", q, k) * (Dh ** -0.5)
        p = _softmax(scores, axis=-1)
        o = torch.einsum("bhqk,bhkd->bhqd", p, v)
        return (lambda x, *d: x.permute(*d))(o, 0, 2, 1, 3).reshape(B, S, D) @ wo

    def _B_ref(x, w1, b1, w2):
        h = torch.einsum("bsd,df->bsf", x, w1) + b1
        sp = torch.log1p(torch.exp(-torch.abs(h))) + torch.where(h > 0, h, torch.zeros_like(h))
        act = h * torch.tanh(sp)
        return torch.einsum("bsf,fd->bsd", act, w2)

    x = A_x
    xn = _layernorm(x, axis=-1)
    return x + _A_ref(xn, A_wqkv, A_wo) + _B_ref(xn, B_w1, B_b1, B_w2)
```

```asm
; @launch kernel=gemm1_kernel grid=(256,1,1) block=(512,1,1) lds=163840
; @launch kernel=attn_kernel grid=(256,1,1) block=(512,1,1) lds=131136
.amdgcn_target "amdgcn-amd-amdhsa--gfx950"
.text
.globl gemm1_kernel
.p2align 8
.type gemm1_kernel,@function
gemm1_kernel:

    s_cmp_ge_u32 s2, 256
    s_cbranch_scc1 gemm1_kernel_end
    s_load_dwordx4 s[4:7], s[0:1], 0
    s_load_dwordx4 s[12:15], s[0:1], 32
    s_load_dwordx2 s[18:19], s[0:1], 16
    s_load_dwordx2 s[16:17], s[0:1], 48
    s_load_dwordx2 s[20:21], s[0:1], 72
    v_and_b32 v1, 63, v0
    v_lshrrev_b32 v5, 6, v0
    v_lshlrev_b32 v2, 4, v1
    v_readfirstlane_b32 s52, v5
    s_and_b32 s60, s2, 7
    s_lshr_b32 s61, s2, 3
    s_and_b32 s62, s60, 1
    s_lshl_b32 s62, s62, 3
    s_and_b32 s63, s61, 7
    s_add_u32 s55, s62, s63
    s_lshr_b32 s62, s60, 1
    s_lshl_b32 s62, s62, 2
    s_lshr_b32 s65, s61, 3
    s_and_b32 s56, s65, 1
    s_lshl_b32 s56, s56, 1
    s_lshr_b32 s60, s65, 1
    s_add_u32 s56, s56, s60
    s_add_u32 s56, s56, s62
    s_lshl_b32 s65, s65, 1
    s_add_u32 s65, s65, s63
    s_and_b32 s78, s65, 7
    s_and_b32 s53, s52, 3
    s_lshr_b32 s54, s52, 2
    s_lshr_b32 s60, s56, 1
    s_mul_i32 s57, s60, 7
    s_and_b32 s60, s56, 1
    s_xor_b32 s64, s60, 1
    s_lshl_b32 s60, s60, 2
    s_add_u32 s57, s57, s60
    s_lshl_b32 s58, s55, 2
    s_add_u32 s58, s58, s53
    v_lshrrev_b32 v5, 3, v1
    v_lshlrev_b32 v5, 10, v5
    v_lshrrev_b32 v6, 4, v1
    v_and_b32 v3, 7, v1
    v_xor_b32 v3, v3, v6
    v_lshlrev_b32 v3, 4, v3
    v_add_u32 v48, v5, v3
    v_xor_b32 v49, 64, v48
    v_lshrrev_b32 v5, 2, v1
    v_and_b32 v6, 3, v1
    v_lshlrev_b32 v6, 4, v6
    v_mul_u32_u24 v51, 3584, v5
    v_add_u32 v51, v51, v6
    v_mul_u32_u24 v50, 3072, v5
    v_add_u32 v50, v50, v6
    v_lshlrev_b32 v52, 10, v5
    v_add_u32 v52, v52, v6
    s_lshl_b32 s69, s55, 17
    s_lshl_b32 s60, s52, 14
    s_add_u32 s69, s69, s60
    s_lshl_b32 s70, s52, 11
    s_lshl_b32 s75, s53, 10
    s_lshl_b32 s60, s54, 13
    s_add_u32 s75, s75, s60
    s_add_u32 s75, s75, 16384
    s_mul_i32 s60, s53, 57344
    s_mul_i32 s61, s53, 49152
    s_lshl_b32 s62, s57, 6
    s_lshl_b32 s63, s56, 6
    s_add_u32 s62, s62, s60
    s_add_u32 s63, s63, s61
    s_lshl_b32 s60, s54, 7
    s_add_u32 s71, s62, s60
    s_add_u32 s72, s71, 64
    s_lshl_b32 s60, s54, 11
    s_add_u32 s73, s63, s60
    s_add_u32 s74, s63, 1024
    s_mov_b32 s26, 2097152
    s_mov_b32 s27, 0x20000
    s_mov_b32 s34, 1835008
    s_mov_b32 s35, 0x20000
    s_waitcnt lgkmcnt(0)
    s_mov_b32 s24, s4
    s_and_b32 s25, s5, 0xffff
    s_mov_b32 s32, s12
    s_and_b32 s33, s13, 0xffff
    s_cmp_eq_u32 s54, 0
    s_cbranch_scc0 gemm1_kernel_p1
    s_lshl_b32 s60, s78, 7
    s_add_u32 s60, s60, s69
    s_mul_i32 s61, s78, 229376
    s_add_u32 s78, s78, 1
    s_and_b32 s78, s78, 7
    s_add_u32 m0, s70, 0
    s_add_u32 s63, s60, 7168
    buffer_load_dwordx4 v48, s[24:27], s60 offen lds
    buffer_load_dwordx4 v49, s[24:27], s63 offen offset:1024 lds
    s_add_u32 m0, s75, 0
    s_add_u32 s63, s61, s71
    buffer_load_dwordx4 v51, s[32:35], s63 offen lds
    s_add_u32 m0, s75, 4096
    s_add_u32 s63, s61, s72
    buffer_load_dwordx4 v51, s[32:35], s63 offen lds
    s_branch gemm1_kernel_p2
gemm1_kernel_p1:
    s_lshl_b32 s60, s78, 7
    s_add_u32 s60, s60, s69
    s_mul_i32 s61, s78, 229376
    s_add_u32 s78, s78, 1
    s_and_b32 s78, s78, 7
    s_add_u32 m0, s70, 0
    s_add_u32 s63, s60, 7168
    buffer_load_dwordx4 v48, s[24:27], s60 offen lds
    buffer_load_dwordx4 v49, s[24:27], s63 offen offset:1024 lds
    s_add_u32 m0, s75, 0
    s_add_u32 s63, s61, s71
    buffer_load_dwordx4 v51, s[32:35], s63 offen lds
    s_cmp_eq_u32 s64, 0
    s_cbranch_scc1 gemm1_kernel_od0
    s_add_u32 m0, s75, 4096
    s_add_u32 s63, s61, s72
    buffer_load_dwordx4 v51, s[32:35], s63 offen lds
gemm1_kernel_od0:
gemm1_kernel_p2:
    s_mov_b32 s28, s6
    s_and_b32 s29, s7, 0xffff
    s_mov_b32 s30, 1572864
    s_mov_b32 s31, 0x20000
    s_mov_b32 s36, s20
    s_and_b32 s37, s21, 0xffff
    s_mov_b32 s38, 268435456
    s_mov_b32 s39, 0x20000
    s_mov_b32 s40, s14
    s_and_b32 s41, s15, 0xffff
    s_mov_b32 s42, 3584
    s_mov_b32 s43, 0x20000
    s_mov_b32 s44, s16
    s_and_b32 s45, s17, 0xffff
    s_mov_b32 s46, 1835008
    s_mov_b32 s47, 0x20000
    s_mov_b32 s48, s18
    s_and_b32 s49, s19, 0xffff
    s_mov_b32 s50, 524288
    s_mov_b32 s51, 0x20000
    s_barrier
    s_cmp_eq_u32 s54, 0
    s_cbranch_scc0 gemm1_kernel_p3
    s_lshl_b32 s60, s78, 7
    s_add_u32 s60, s60, s69
    s_mul_i32 s61, s78, 229376
    s_add_u32 s78, s78, 1
    s_and_b32 s78, s78, 7
    s_add_u32 m0, s70, 32768
    s_add_u32 s63, s60, 7168
    buffer_load_dwordx4 v48, s[24:27], s60 offen lds
    buffer_load_dwordx4 v49, s[24:27], s63 offen offset:1024 lds
    s_add_u32 m0, s75, 32768
    s_add_u32 s63, s61, s71
    buffer_load_dwordx4 v51, s[32:35], s63 offen lds
    s_add_u32 m0, s75, 36864
    s_add_u32 s63, s61, s72
    buffer_load_dwordx4 v51, s[32:35], s63 offen lds
    s_branch gemm1_kernel_p4
gemm1_kernel_p3:
    s_lshl_b32 s60, s78, 7
    s_add_u32 s60, s60, s69
    s_mul_i32 s61, s78, 229376
    s_add_u32 s78, s78, 1
    s_and_b32 s78, s78, 7
    s_add_u32 m0, s70, 32768
    s_add_u32 s63, s60, 7168
    buffer_load_dwordx4 v48, s[24:27], s60 offen lds
    buffer_load_dwordx4 v49, s[24:27], s63 offen offset:1024 lds
    s_add_u32 m0, s75, 32768
    s_add_u32 s63, s61, s71
    buffer_load_dwordx4 v51, s[32:35], s63 offen lds
    s_cmp_eq_u32 s64, 0
    s_cbranch_scc1 gemm1_kernel_od1b
    s_add_u32 m0, s75, 36864
    s_add_u32 s63, s61, s72
    buffer_load_dwordx4 v51, s[32:35], s63 offen lds
gemm1_kernel_od1b:
gemm1_kernel_p4:
    s_cmp_lt_u32 s2, 40
    s_cbranch_scc0 gemm1_kernel_nz
    s_cmp_eq_u32 s52, 0
    s_cbranch_scc0 gemm1_kernel_nz
    s_lshl_b32 s60, s2, 8
    s_cmp_lt_u32 s2, 32
    s_cselect_b32 s61, 0, 57344
    s_add_u32 s60, s60, s61
    s_add_u32 s60, s60, 31457280
    v_mov_b32 v3, 0
    v_lshlrev_b32 v5, 2, v1
    buffer_store_dword v3, v5, s[36:39], s60 offen
gemm1_kernel_nz:
    s_lshl_b32 s60, s2, 3
    s_add_u32 s60, s60, s52
    s_lshl_b32 s60, s60, 10
    s_add_u32 s60, s60, 6291456
    v_mov_b32 v224, -1
    v_mov_b32 v225, -1
    v_mov_b32 v226, -1
    v_mov_b32 v227, -1
    buffer_store_dwordx4 v[224:227], v2, s[36:39], s60 offen sc1
    v_mov_b32 v64, 0
    v_mov_b32 v65, 0
    v_mov_b32 v66, 0
    v_mov_b32 v67, 0
    v_mov_b32 v68, 0
    v_mov_b32 v69, 0
    v_mov_b32 v70, 0
    v_mov_b32 v71, 0
    v_mov_b32 v72, 0
    v_mov_b32 v73, 0
    v_mov_b32 v74, 0
    v_mov_b32 v75, 0
    v_mov_b32 v76, 0
    v_mov_b32 v77, 0
    v_mov_b32 v78, 0
    v_mov_b32 v79, 0
    v_mov_b32 v80, 0
    v_mov_b32 v81, 0
    v_mov_b32 v82, 0
    v_mov_b32 v83, 0
    v_mov_b32 v84, 0
    v_mov_b32 v85, 0
    v_mov_b32 v86, 0
    v_mov_b32 v87, 0
    v_mov_b32 v88, 0
    v_mov_b32 v89, 0
    v_mov_b32 v90, 0
    v_mov_b32 v91, 0
    v_mov_b32 v92, 0
    v_mov_b32 v93, 0
    v_mov_b32 v94, 0
    v_mov_b32 v95, 0
    v_mov_b32 v96, 0
    v_mov_b32 v97, 0
    v_mov_b32 v98, 0
    v_mov_b32 v99, 0
    v_mov_b32 v100, 0
    v_mov_b32 v101, 0
    v_mov_b32 v102, 0
    v_mov_b32 v103, 0
    v_mov_b32 v104, 0
    v_mov_b32 v105, 0
    v_mov_b32 v106, 0
    v_mov_b32 v107, 0
    v_mov_b32 v108, 0
    v_mov_b32 v109, 0
    v_mov_b32 v110, 0
    v_mov_b32 v111, 0
    v_mov_b32 v112, 0
    v_mov_b32 v113, 0
    v_mov_b32 v114, 0
    v_mov_b32 v115, 0
    v_mov_b32 v116, 0
    v_mov_b32 v117, 0
    v_mov_b32 v118, 0
    v_mov_b32 v119, 0
    v_mov_b32 v120, 0
    v_mov_b32 v121, 0
    v_mov_b32 v122, 0
    v_mov_b32 v123, 0
    v_mov_b32 v124, 0
    v_mov_b32 v125, 0
    v_mov_b32 v126, 0
    v_mov_b32 v127, 0
    v_mov_b32 v192, 0
    v_mov_b32 v193, 0
    v_mov_b32 v194, 0
    v_mov_b32 v195, 0
    v_mov_b32 v196, 0
    v_mov_b32 v197, 0
    v_mov_b32 v198, 0
    v_mov_b32 v199, 0
    v_mov_b32 v200, 0
    v_mov_b32 v201, 0
    v_mov_b32 v202, 0
    v_mov_b32 v203, 0
    v_mov_b32 v204, 0
    v_mov_b32 v205, 0
    v_mov_b32 v206, 0
    v_mov_b32 v207, 0
    v_mov_b32 v208, 0
    v_mov_b32 v209, 0
    v_mov_b32 v210, 0
    v_mov_b32 v211, 0
    v_mov_b32 v212, 0
    v_mov_b32 v213, 0
    v_mov_b32 v214, 0
    v_mov_b32 v215, 0
    v_mov_b32 v216, 0
    v_mov_b32 v217, 0
    v_mov_b32 v218, 0
    v_mov_b32 v219, 0
    v_mov_b32 v220, 0
    v_mov_b32 v221, 0
    v_mov_b32 v222, 0
    v_mov_b32 v223, 0
    v_mov_b32 v20, 0
    v_mov_b32 v21, 0
    v_mov_b32 v22, 0
    v_mov_b32 v23, 0
    v_lshrrev_b32 v5, 5, v1
    v_lshlrev_b32 v5, 9, v5
    v_bfe_u32 v6, v1, 2, 2
    v_lshlrev_b32 v6, 6, v6
    v_add_u32 v5, v5, v6
    v_bfe_u32 v6, v1, 4, 1
    v_lshlrev_b32 v6, 5, v6
    v_add_u32 v5, v5, v6
    v_and_b32 v6, 3, v1
    v_lshlrev_b32 v6, 3, v6
    v_add_u32 v4, v5, v6
    v_lshrrev_b32 v6, 5, v1
    v_lshlrev_b32 v6, 8, v6
    v_sub_u32 v54, v4, v6
    s_lshl_b32 s60, s54, 13
    s_add_u32 s60, s60, 16384
    v_add_u32 v4, s60, v4
    v_and_b32 v5, 31, v1
    v_lshlrev_b32 v6, 7, v5
    s_lshl_b32 s60, s53, 12
    v_add_u32 v6, s60, v6
    v_bfe_u32 v3, v1, 1, 3
    v_lshrrev_b32 v5, 5, v1
    v_xor_b32 v3, v3, v5
    v_lshlrev_b32 v3, 4, v3
    v_add_u32 v6, v6, v3
    s_add_u32 s60, s53, 0
    s_and_b32 s60, s60, 3
    s_lshl_b32 s61, s60, 10
    v_add_u32 v56, s61, v4
    v_add_u32 v28, 0x10000, v56
    s_lshl_b32 s61, s60, 5
    v_xor_b32 v40, s61, v6
    v_add_u32 v44, 0x10000, v40
    s_add_u32 s60, s53, 1
    s_and_b32 s60, s60, 3
    s_lshl_b32 s61, s60, 10
    v_add_u32 v57, s61, v4
    v_add_u32 v29, 0x10000, v57
    s_lshl_b32 s61, s60, 5
    v_xor_b32 v41, s61, v6
    v_add_u32 v45, 0x10000, v41
    s_add_u32 s60, s53, 2
    s_and_b32 s60, s60, 3
    s_lshl_b32 s61, s60, 10
    v_add_u32 v58, s61, v4
    v_add_u32 v30, 0x10000, v58
    s_lshl_b32 s61, s60, 5
    v_xor_b32 v42, s61, v6
    v_add_u32 v46, 0x10000, v42
    s_add_u32 s60, s53, 3
    s_and_b32 s60, s60, 3
    s_lshl_b32 s61, s60, 10
    v_add_u32 v59, s61, v4
    v_add_u32 v31, 0x10000, v59
    s_lshl_b32 s61, s60, 5
    v_xor_b32 v43, s61, v6
    v_add_u32 v47, 0x10000, v43
    v_bfe_u32 v5, v1, 4, 1
    v_lshlrev_b32 v5, 16, v5
    v_lshrrev_b32 v3, 5, v1
    v_lshlrev_b32 v3, 8, v3
    v_add_u32 v5, v5, v3
    v_and_b32 v3, 15, v1
    v_lshlrev_b32 v3, 4, v3
    v_add_u32 v53, v5, v3
    v_and_b32 v5, 15, v1
    v_bfe_u32 v6, v1, 4, 1
    v_cmp_eq_u32 vcc, v5, v6
    v_mov_b32 v5, 0x3f803f80
    s_nop 0
    v_cndmask_b32 v8, 0, v5, vcc
    v_cndmask_b32 v9, 0, v5, vcc
    v_cndmask_b32 v10, 0, v5, vcc
    v_cndmask_b32 v11, 0, v5, vcc
    s_lshl_b32 s60, s54, 1
    s_add_u32 s60, s60, s57
    s_lshl_b32 s60, s60, 6
    v_and_b32 v5, 31, v1
    v_lshlrev_b32 v5, 1, v5
    buffer_load_ushort v61, v5, s[40:43], s60 offen
    buffer_load_ushort v62, v5, s[40:43], s60 offen offset:64
    s_getpc_b64 s[86:87]
gemm1_kernel_pc:
    v_lshlrev_b32 v5, 7, v1
    s_lshl_b32 s60, s52, 13
    v_add_u32 v5, s60, v5
    s_mov_b32 s61, TEXT_END-gemm1_kernel_pc-4
    v_min_u32 v5, s61, v5
    global_load_dword v3, v5, s[86:87]
    s_cmp_eq_u32 s54, 0
    s_cbranch_scc0 gemm1_kernel_g1
    s_waitcnt vmcnt(8)
    s_barrier
    ds_read_b128 v[160:163], v40 offset:0
    ds_read_b128 v[164:167], v41 offset:0
    ds_read_b128 v[168:171], v42 offset:0
    ds_read_b128 v[172:175], v43 offset:0
    ds_read_b64_tr_b16 v[128:129], v56 offset:0
    ds_read_b64_tr_b16 v[130:131], v56 offset:256
    ds_read_b64_tr_b16 v[132:133], v57 offset:0
    ds_read_b64_tr_b16 v[134:135], v57 offset:256
    ds_read_b64_tr_b16 v[136:137], v58 offset:0
    ds_read_b64_tr_b16 v[138:139], v58 offset:256
    ds_read_b64_tr_b16 v[140:141], v59 offset:0
    ds_read_b64_tr_b16 v[142:143], v59 offset:256
    ds_read_b64_tr_b16 v[144:145], v56 offset:4096
    ds_read_b64_tr_b16 v[146:147], v56 offset:4352
    ds_read_b64_tr_b16 v[148:149], v57 offset:4096
    ds_read_b64_tr_b16 v[150:151], v57 offset:4352
    ds_read_b64_tr_b16 v[152:153], v58 offset:4096
    ds_read_b64_tr_b16 v[154:155], v58 offset:4352
    ds_read_b64_tr_b16 v[156:157], v59 offset:4096
    ds_read_b64_tr_b16 v[158:159], v59 offset:4352
    s_lshl_b32 s60, s78, 7
    s_add_u32 s60, s60, s69
    s_mul_i32 s61, s78, 229376
    s_add_u32 s78, s78, 1
    s_and_b32 s78, s78, 7
    s_add_u32 m0, s70, 65536
    s_add_u32 s63, s60, 7168
    buffer_load_dwordx4 v48, s[24:27], s60 offen lds
    buffer_load_dwordx4 v49, s[24:27], s63 offen offset:1024 lds
    s_add_u32 m0, s75, 65536
    s_add_u32 s63, s61, s71
    buffer_load_dwordx4 v51, s[32:35], s63 offen lds
    s_add_u32 m0, s75, 69632
    s_add_u32 s63, s61, s72
    buffer_load_dwordx4 v51, s[32:35], s63 offen lds
    s_waitcnt vmcnt(8)
    s_barrier
    s_waitcnt lgkmcnt(8)
    v_mfma_f32_16x16x32_bf16 v[208:211], v[8:11], v[128:131], v[208:211]
    v_mfma_f32_32x32x16_bf16 v[64:79], v[128:131], v[160:163], v[64:79]
    ds_read_b64_tr_b16 v[128:129], v56 offset:32768
    ds_read_b64_tr_b16 v[130:131], v56 offset:33024
    ds_read_b128 v[176:179], v40 offset:32768
    v_mfma_f32_32x32x16_bf16 v[64:79], v[132:135], v[164:167], v[64:79]
    ds_read_b64_tr_b16 v[132:133], v57 offset:32768
    ds_read_b64_tr_b16 v[134:135], v57 offset:33024
    ds_read_b128 v[180:183], v41 offset:32768
    s_lshl_b32 s60, s78, 7
    s_add_u32 s60, s60, s69
    s_mul_i32 s61, s78, 229376
    s_add_u32 s78, s78, 1
    s_and_b32 s78, s78, 7
    s_add_u32 m0, s70, 98304
    s_add_u32 s63, s60, 7168
    buffer_load_dwordx4 v48, s[24:27], s60 offen lds
    buffer_load_dwordx4 v49, s[24:27], s63 offen offset:1024 lds
    v_mfma_f32_32x32x16_bf16 v[64:79], v[136:139], v[168:171], v[64:79]
    ds_read_b64_tr_b16 v[136:137], v58 offset:32768
    ds_read_b64_tr_b16 v[138:139], v58 offset:33024
    ds_read_b128 v[184:187], v42 offset:32768
    v_mfma_f32_32x32x16_bf16 v[64:79], v[140:143], v[172:175], v[64:79]
    ds_read_b64_tr_b16 v[140:141], v59 offset:32768
    ds_read_b64_tr_b16 v[142:143], v59 offset:33024
    ds_read_b128 v[188:191], v43 offset:32768
    s_add_u32 m0, s75, 98304
    s_add_u32 s63, s61, s71
    buffer_load_dwordx4 v51, s[32:35], s63 offen lds
    s_waitcnt lgkmcnt(12)
    v_mfma_f32_16x16x32_bf16 v[212:215], v[8:11], v[144:147], v[212:215]
    v_mfma_f32_32x32x16_bf16 v[80:95], v[144:147], v[160:163], v[80:95]
    ds_read_b64_tr_b16 v[144:145], v56 offset:36864
    ds_read_b64_tr_b16 v[146:147], v56 offset:37120
    v_mfma_f32_32x32x16_bf16 v[80:95], v[148:151], v[164:167], v[80:95]
    ds_read_b64_tr_b16 v[148:149], v57 offset:36864
    ds_read_b64_tr_b16 v[150:151], v57 offset:37120
    v_mfma_f32_32x32x16_bf16 v[80:95], v[152:155], v[168:171], v[80:95]
    ds_read_b64_tr_b16 v[152:153], v58 offset:36864
    ds_read_b64_tr_b16 v[154:155], v58 offset:37120
    v_mfma_f32_32x32x16_bf16 v[80:95], v[156:159], v[172:175], v[80:95]
    ds_read_b64_tr_b16 v[156:157], v59 offset:36864
    ds_read_b64_tr_b16 v[158:159], v59 offset:37120
    s_add_u32 m0, s75, 102400
    s_add_u32 s63, s61, s72
    buffer_load_dwordx4 v51, s[32:35], s63 offen lds
    v_mfma_f32_32x32x16_bf16 v[192:207], v[160:163], v[160:163], v[192:207]
    v_mfma_f32_32x32x16_bf16 v[192:207], v[164:167], v[164:167], v[192:207]
    v_mfma_f32_32x32x16_bf16 v[192:207], v[168:171], v[168:171], v[192:207]
    v_mfma_f32_32x32x16_bf16 v[192:207], v[172:175], v[172:175], v[192:207]
    s_waitcnt vmcnt(4)
    s_barrier
    s_waitcnt lgkmcnt(8)
    v_mfma_f32_16x16x32_bf16 v[208:211], v[8:11], v[128:131], v[208:211]
    v_mfma_f32_32x32x16_bf16 v[64:79], v[128:131], v[176:179], v[64:79]
    ds_read_b64_tr_b16 v[128:129], v28 offset:0
    ds_read_b64_tr_b16 v[130:131], v28 offset:256
    ds_read_b128 v[160:163], v44 offset:0
    v_mfma_f32_32x32x16_bf16 v[64:79], v[132:135], v[180:183], v[64:79]
    ds_read_b64_tr_b16 v[132:133], v29 offset:0
    ds_read_b64_tr_b16 v[134:135], v29 offset:256
    ds_read_b128 v[164:167], v45 offset:0
    s_lshl_b32 s60, s78, 7
    s_add_u32 s60, s60, s69
    s_mul_i32 s61, s78, 229376
    s_add_u32 s78, s78, 1
    s_and_b32 s78, s78, 7
    s_add_u32 m0, s70, 0
    s_add_u32 s63, s60, 7168
    buffer_load_dwordx4 v48, s[24:27], s60 offen lds
    buffer_load_dwordx4 v49, s[24:27], s63 offen offset:1024 lds
    v_mfma_f32_32x32x16_bf16 v[64:79], v[136:139], v[184:187], v[64:79]
    ds_read_b64_tr_b16 v[136:137], v30 offset:0
    ds_read_b64_tr_b16 v[138:139], v30 offset:256
    ds_read_b128 v[168:171], v46 offset:0
    v_mfma_f32_32x32x16_bf16 v[64:79], v[140:143], v[188:191], v[64:79]
    ds_read_b64_tr_b16 v[140:141], v31 offset:0
    ds_read_b64_tr_b16 v[142:143], v31 offset:256
    ds_read_b128 v[172:175], v47 offset:0
    s_add_u32 m0, s75, 0
    s_add_u32 s63, s61, s71
    buffer_load_dwordx4 v51, s[32:35], s63 offen lds
    s_waitcnt lgkmcnt(12)
    v_mfma_f32_16x16x32_bf16 v[212:215], v[8:11], v[144:147], v[212:215]
    v_mfma_f32_32x32x16_bf16 v[80:95], v[144:147], v[176:179], v[80:95]
    ds_read_b64_tr_b16 v[144:145], v28 offset:4096
    ds_read_b64_tr_b16 v[146:147], v28 offset:4352
    v_mfma_f32_32x32x16_bf16 v[80:95], v[148:151], v[180:183], v[80:95]
    ds_read_b64_tr_b16 v[148:149], v29 offset:4096
    ds_read_b64_tr_b16 v[150:151], v29 offset:4352
    v_mfma_f32_32x32x16_bf16 v[80:95], v[152:155], v[184:187], v[80:95]
    ds_read_b64_tr_b16 v[152:153], v30 offset:4096
    ds_read_b64_tr_b16 v[154:155], v30 offset:4352
    v_mfma_f32_32x32x16_bf16 v[80:95], v[156:159], v[188:191], v[80:95]
    ds_read_b64_tr_b16 v[156:157], v31 offset:4096
    ds_read_b64_tr_b16 v[158:159], v31 offset:4352
    s_add_u32 m0, s75, 4096
    s_add_u32 s63, s61, s72
    buffer_load_dwordx4 v51, s[32:35], s63 offen lds
    v_mfma_f32_32x32x16_bf16 v[192:207], v[176:179], v[176:179], v[192:207]
    v_mfma_f32_32x32x16_bf16 v[192:207], v[180:183], v[180:183], v[192:207]
    v_mfma_f32_32x32x16_bf16 v[192:207], v[184:187], v[184:187], v[192:207]
    v_mfma_f32_32x32x16_bf16 v[192:207], v[188:191], v[188:191], v[192:207]
    s_waitcnt vmcnt(4)
    s_barrier
    s_waitcnt lgkmcnt(8)
    v_mfma_f32_16x16x32_bf16 v[208:211], v[8:11], v[128:131], v[208:211]
    v_mfma_f32_32x32x16_bf16 v[64:79], v[128:131], v[160:163], v[64:79]
    ds_read_b64_tr_b16 v[128:129], v28 offset:32768
    ds_read_b64_tr_b16 v[130:131], v28 offset:33024
    ds_read_b128 v[176:179], v44 offset:32768
    v_mfma_f32_32x32x16_bf16 v[64:79], v[132:135], v[164:167], v[64:79]
    ds_read_b64_tr_b16 v[132:133], v29 offset:32768
    ds_read_b64_tr_b16 v[134:135], v29 offset:33024
    ds_read_b128 v[180:183], v45 offset:32768
    s_lshl_b32 s60, s78, 7
    s_add_u32 s60, s60, s69
    s_mul_i32 s61, s78, 229376
    s_add_u32 s78, s78, 1
    s_and_b32 s78, s78, 7
    s_add_u32 m0, s70, 32768
    s_add_u32 s63, s60, 7168
    buffer_load_dwordx4 v48, s[24:27], s60 offen lds
    buffer_load_dwordx4 v49, s[24:27], s63 offen offset:1024 lds
    v_mfma_f32_32x32x16_bf16 v[64:79], v[136:139], v[168:171], v[64:79]
    ds_read_b64_tr_b16 v[136:137], v30 offset:32768
    ds_read_b64_tr_b16 v[138:139], v30 offset:33024
    ds_read_b128 v[184:187], v46 offset:32768
    v_mfma_f32_32x32x16_bf16 v[64:79], v[140:143], v[172:175], v[64:79]
    ds_read_b64_tr_b16 v[140:141], v31 offset:32768
    ds_read_b64_tr_b16 v[142:143], v31 offset:33024
    ds_read_b128 v[188:191], v47 offset:32768
    s_add_u32 m0, s75, 32768
    s_add_u32 s63, s61, s71
    buffer_load_dwordx4 v51, s[32:35], s63 offen lds
    s_waitcnt lgkmcnt(12)
    v_mfma_f32_16x16x32_bf16 v[212:215], v[8:11], v[144:147], v[212:215]
    v_mfma_f32_32x32x16_bf16 v[80:95], v[144:147], v[160:163], v[80:95]
    ds_read_b64_tr_b16 v[144:145], v28 offset:36864
    ds_read_b64_tr_b16 v[146:147], v28 offset:37120
    v_mfma_f32_32x32x16_bf16 v[80:95], v[148:151], v[164:167], v[80:95]
    ds_read_b64_tr_b16 v[148:149], v29 offset:36864
    ds_read_b64_tr_b16 v[150:151], v29 offset:37120
    v_mfma_f32_32x32x16_bf16 v[80:95], v[152:155], v[168:171], v[80:95]
    ds_read_b64_tr_b16 v[152:153], v30 offset:36864
    ds_read_b64_tr_b16 v[154:155], v30 offset:37120
    v_mfma_f32_32x32x16_bf16 v[80:95], v[156:159], v[172:175], v[80:95]
    ds_read_b64_tr_b16 v[156:157], v31 offset:36864
    ds_read_b64_tr_b16 v[158:159], v31 offset:37120
    s_add_u32 m0, s75, 36864
    s_add_u32 s63, s61, s72
    buffer_load_dwordx4 v51, s[32:35], s63 offen lds
    v_mfma_f32_32x32x16_bf16 v[192:207], v[160:163], v[160:163], v[192:207]
    v_mfma_f32_32x32x16_bf16 v[192:207], v[164:167], v[164:167], v[192:207]
    v_mfma_f32_32x32x16_bf16 v[192:207], v[168:171], v[168:171], v[192:207]
    v_mfma_f32_32x32x16_bf16 v[192:207], v[172:175], v[172:175], v[192:207]
    s_and_b32 s60, s2, 15
    s_lshr_b32 s63, s2, 4
    s_mul_i32 s61, s60, 7
    s_add_u32 s61, s61, s52
    s_lshl_b32 s62, s60, 1
    s_cmp_eq_u32 s52, 7
    s_cselect_b32 s88, s48, s44
    s_cselect_b32 s89, s49, s45
    s_cselect_b32 s90, s50, s46
    s_mov_b32 s91, 0x20000
    s_cselect_b32 s61, s62, s61
    s_cselect_b32 s93, 32, 0x70
    s_cselect_b32 s94, 2097152, 0
    s_mul_i32 s93, s93, s63
    s_add_u32 s93, s93, s61
    s_lshl_b32 s93, s93, 10
    s_add_u32 s93, s93, s94
    s_add_u32 s93, s93, 16777216
    s_lshl_b32 s61, s61, 14
    s_lshl_b32 s63, s63, 6
    s_add_u32 s61, s61, s63
    s_lshl_b32 s95, s52, 10
    s_add_u32 m0, s95, 139264
    s_lshl_b32 s62, s62, 14
    buffer_load_dwordx4 v52, s[88:91], s61 offen lds
    s_add_u32 s62, s62, s63
    s_add_u32 s62, s62, 16384
    s_mov_b32 m0, 147456
    s_lshr_b32 s63, s2, 4
    s_lshl_b32 s94, s63, 5
    buffer_load_dwordx4 v52, s[48:51], s62 offen lds
    s_lshl_b32 s60, s60, 1
    s_add_u32 s94, s94, s60
    s_add_u32 s94, s94, 1
    s_lshl_b32 s94, s94, 10
    s_add_u32 s94, s94, 18874368
    s_waitcnt vmcnt(6)
    s_barrier
    s_waitcnt lgkmcnt(8)
    v_mfma_f32_16x16x32_bf16 v[208:211], v[8:11], v[128:131], v[208:211]
    v_mfma_f32_32x32x16_bf16 v[64:79], v[128:131], v[176:179], v[64:79]
    ds_read_b64_tr_b16 v[128:129], v56 offset:0
    ds_read_b64_tr_b16 v[130:131], v56 offset:256
    ds_read_b128 v[160:163], v40 offset:0
    v_mfma_f32_32x32x16_bf16 v[64:79], v[132:135], v[180:183], v[64:79]
    ds_read_b64_tr_b16 v[132:133], v57 offset:0
    ds_read_b64_tr_b16 v[134:135], v57 offset:256
    ds_read_b128 v[164:167], v41 offset:0
    s_lshl_b32 s60, s78, 7
    s_add_u32 s60, s60, s69
    s_mul_i32 s61, s78, 229376
    s_add_u32 s78, s78, 1
    s_and_b32 s78, s78, 7
    s_add_u32 m0, s70, 65536
    s_add_u32 s63, s60, 7168
    buffer_load_dwordx4 v48, s[24:27], s60 offen lds
    buffer_load_dwordx4 v49, s[24:27], s63 offen offset:1024 lds
    v_mfma_f32_32x32x16_bf16 v[64:79], v[136:139], v[184:187], v[64:79]
    ds_read_b64_tr_b16 v[136:137], v58 offset:0
    ds_read_b64_tr_b16 v[138:139], v58 offset:256
    ds_read_b128 v[168:171], v42 offset:0
    v_mfma_f32_32x32x16_bf16 v[64:79], v[140:143], v[188:191], v[64:79]
    ds_read_b64_tr_b16 v[140:141], v59 offset:0
    ds_read_b64_tr_b16 v[142:143], v59 offset:256
    ds_read_b128 v[172:175], v43 offset:0
    s_add_u32 m0, s75, 65536
    s_add_u32 s63, s61, s71
    buffer_load_dwordx4 v51, s[32:35], s63 offen lds
    s_waitcnt lgkmcnt(12)
    v_mfma_f32_16x16x32_bf16 v[212:215], v[8:11], v[144:147], v[212:215]
    v_mfma_f32_32x32x16_bf16 v[80:95], v[144:147], v[176:179], v[80:95]
    ds_read_b64_tr_b16 v[144:145], v56 offset:4096
    ds_read_b64_tr_b16 v[146:147], v56 offset:4352
    v_mfma_f32_32x32x16_bf16 v[80:95], v[148:151], v[180:183], v[80:95]
    ds_read_b64_tr_b16 v[148:149], v57 offset:4096
    ds_read_b64_tr_b16 v[150:151], v57 offset:4352
    v_mfma_f32_32x32x16_bf16 v[80:95], v[152:155], v[184:187], v[80:95]
    ds_read_b64_tr_b16 v[152:153], v58 offset:4096
    ds_read_b64_tr_b16 v[154:155], v58 offset:4352
    v_mfma_f32_32x32x16_bf16 v[80:95], v[156:159], v[188:191], v[80:95]
    ds_read_b64_tr_b16 v[156:157], v59 offset:4096
    ds_read_b64_tr_b16 v[158:159], v59 offset:4352
    s_add_u32 m0, s75, 69632
    s_add_u32 s63, s61, s72
    buffer_load_dwordx4 v51, s[32:35], s63 offen lds
    v_mfma_f32_32x32x16_bf16 v[192:207], v[176:179], v[176:179], v[192:207]
    v_mfma_f32_32x32x16_bf16 v[192:207], v[180:183], v[180:183], v[192:207]
    v_mfma_f32_32x32x16_bf16 v[192:207], v[184:187], v[184:187], v[192:207]
    v_mfma_f32_32x32x16_bf16 v[192:207], v[188:191], v[188:191], v[192:207]
    s_waitcnt vmcnt(6)
    s_barrier
    s_waitcnt lgkmcnt(8)
    v_mfma_f32_16x16x32_bf16 v[208:211], v[8:11], v[128:131], v[208:211]
    v_mfma_f32_32x32x16_bf16 v[64:79], v[128:131], v[160:163], v[64:79]
    ds_read_b64_tr_b16 v[128:129], v56 offset:32768
    ds_read_b64_tr_b16 v[130:131], v56 offset:33024
    ds_read_b128 v[176:179], v40 offset:32768
    v_mfma_f32_32x32x16_bf16 v[64:79], v[132:135], v[164:167], v[64:79]
    ds_read_b64_tr_b16 v[132:133], v57 offset:32768
    ds_read_b64_tr_b16 v[134:135], v57 offset:33024
    ds_read_b128 v[180:183], v41 offset:32768
    s_lshl_b32 s60, s78, 7
    s_add_u32 s60, s60, s69
    s_mul_i32 s61, s78, 229376
    s_add_u32 s78, s78, 1
    s_and_b32 s78, s78, 7
    s_add_u32 m0, s70, 98304
    s_add_u32 s63, s60, 7168
    buffer_load_dwordx4 v48, s[24:27], s60 offen lds
    buffer_load_dwordx4 v49, s[24:27], s63 offen offset:1024 lds
    v_mfma_f32_32x32x16_bf16 v[64:79], v[136:139], v[168:171], v[64:79]
    ds_read_b64_tr_b16 v[136:137], v58 offset:32768
    ds_read_b64_tr_b16 v[138:139], v58 offset:33024
    ds_read_b128 v[184:187], v42 offset:32768
    v_mfma_f32_32x32x16_bf16 v[64:79], v[140:143], v[172:175], v[64:79]
    ds_read_b64_tr_b16 v[140:141], v59 offset:32768
    ds_read_b64_tr_b16 v[142:143], v59 offset:33024
    ds_read_b128 v[188:191], v43 offset:32768
    s_add_u32 m0, s75, 98304
    s_add_u32 s63, s61, s71
    buffer_load_dwordx4 v51, s[32:35], s63 offen lds
    s_waitcnt lgkmcnt(12)
    v_mfma_f32_16x16x32_bf16 v[212:215], v[8:11], v[144:147], v[212:215]
    v_mfma_f32_32x32x16_bf16 v[80:95], v[144:147], v[160:163], v[80:95]
    ds_read_b64_tr_b16 v[144:145], v56 offset:36864
    ds_read_b64_tr_b16 v[146:147], v56 offset:37120
    v_mfma_f32_32x32x16_bf16 v[80:95], v[148:151], v[164:167], v[80:95]
    ds_read_b64_tr_b16 v[148:149], v57 offset:36864
    ds_read_b64_tr_b16 v[150:151], v57 offset:37120
    v_mfma_f32_32x32x16_bf16 v[80:95], v[152:155], v[168:171], v[80:95]
    ds_read_b64_tr_b16 v[152:153], v58 offset:36864
    ds_read_b64_tr_b16 v[154:155], v58 offset:37120
    v_mfma_f32_32x32x16_bf16 v[80:95], v[156:159], v[172:175], v[80:95]
    ds_read_b64_tr_b16 v[156:157], v59 offset:36864
    ds_read_b64_tr_b16 v[158:159], v59 offset:37120
    s_add_u32 m0, s75, 102400
    s_add_u32 s63, s61, s72
    buffer_load_dwordx4 v51, s[32:35], s63 offen lds
    v_mfma_f32_32x32x16_bf16 v[192:207], v[160:163], v[160:163], v[192:207]
    v_mfma_f32_32x32x16_bf16 v[192:207], v[164:167], v[164:167], v[192:207]
    v_mfma_f32_32x32x16_bf16 v[192:207], v[168:171], v[168:171], v[192:207]
    v_mfma_f32_32x32x16_bf16 v[192:207], v[172:175], v[172:175], v[192:207]
    s_waitcnt vmcnt(4)
    s_barrier
    s_waitcnt lgkmcnt(8)
    v_mfma_f32_16x16x32_bf16 v[208:211], v[8:11], v[128:131], v[208:211]
    v_mfma_f32_32x32x16_bf16 v[64:79], v[128:131], v[176:179], v[64:79]
    ds_read_b64_tr_b16 v[128:129], v28 offset:0
    ds_read_b64_tr_b16 v[130:131], v28 offset:256
    ds_read_b128 v[160:163], v44 offset:0
    v_mfma_f32_32x32x16_bf16 v[64:79], v[132:135], v[180:183], v[64:79]
    ds_read_b64_tr_b16 v[132:133], v29 offset:0
    ds_read_b64_tr_b16 v[134:135], v29 offset:256
    ds_read_b128 v[164:167], v45 offset:0
    s_lshl_b32 s60, s78, 7
    s_add_u32 s60, s60, s69
    s_mul_i32 s61, s78, 196608
    s_add_u32 s78, s78, 1
    s_and_b32 s78, s78, 7
    s_add_u32 m0, s70, 0
    s_add_u32 s63, s60, 7168
    buffer_load_dwordx4 v48, s[24:27], s60 offen lds
    buffer_load_dwordx4 v49, s[24:27], s63 offen offset:1024 lds
    v_mfma_f32_32x32x16_bf16 v[64:79], v[136:139], v[184:187], v[64:79]
    ds_read_b64_tr_b16 v[136:137], v30 offset:0
    ds_read_b64_tr_b16 v[138:139], v30 offset:256
    ds_read_b128 v[168:171], v46 offset:0
    v_mfma_f32_32x32x16_bf16 v[64:79], v[140:143], v[188:191], v[64:79]
    ds_read_b64_tr_b16 v[140:141], v31 offset:0
    ds_read_b64_tr_b16 v[142:143], v31 offset:256
    ds_read_b128 v[172:175], v47 offset:0
    s_add_u32 m0, s75, 0
    s_add_u32 s63, s61, s73
    buffer_load_dwordx4 v50, s[28:31], s63 offen lds
    s_waitcnt lgkmcnt(12)
    v_mfma_f32_16x16x32_bf16 v[212:215], v[8:11], v[144:147], v[212:215]
    v_mfma_f32_32x32x16_bf16 v[80:95], v[144:147], v[176:179], v[80:95]
    ds_read_b64_tr_b16 v[144:145], v28 offset:4096
    ds_read_b64_tr_b16 v[146:147], v28 offset:4352
    v_mfma_f32_32x32x16_bf16 v[80:95], v[148:151], v[180:183], v[80:95]
    ds_read_b64_tr_b16 v[148:149], v29 offset:4096
    ds_read_b64_tr_b16 v[150:151], v29 offset:4352
    v_mfma_f32_32x32x16_bf16 v[80:95], v[152:155], v[184:187], v[80:95]
    ds_read_b64_tr_b16 v[152:153], v30 offset:4096
    ds_read_b64_tr_b16 v[154:155], v30 offset:4352
    v_mfma_f32_32x32x16_bf16 v[80:95], v[156:159], v[188:191], v[80:95]
    ds_read_b64_tr_b16 v[156:157], v31 offset:4096
    ds_read_b64_tr_b16 v[158:159], v31 offset:4352
    s_add_u32 m0, s75, 4096
    s_add_u32 s63, s61, s74
    buffer_load_dwordx4 v50, s[28:31], s63 offen lds
    v_mfma_f32_32x32x16_bf16 v[192:207], v[176:179], v[176:179], v[192:207]
    v_mfma_f32_32x32x16_bf16 v[192:207], v[180:183], v[180:183], v[192:207]
    v_mfma_f32_32x32x16_bf16 v[192:207], v[184:187], v[184:187], v[192:207]
    v_mfma_f32_32x32x16_bf16 v[192:207], v[188:191], v[188:191], v[192:207]
    s_waitcnt vmcnt(12)
    v_add_u32 v5, s95, v54
    v_add_u32 v5, 139264, v5
    ds_read_b64_tr_b16 v[224:225], v5
    ds_read_b64_tr_b16 v[226:227], v5 offset:512
    v_add_u32 v5, 147456, v54
    ds_read_b64_tr_b16 v[228:229], v5
    ds_read_b64_tr_b16 v[230:231], v5 offset:512
    s_waitcnt lgkmcnt(0)
    buffer_store_dwordx4 v[224:227], v2, s[36:39], s93 offen sc1
    s_cmp_eq_u32 s52, 0
    s_cbranch_scc0 gemm1_kernel_g0_pp
    buffer_store_dwordx4 v[228:231], v2, s[36:39], s94 offen sc1
gemm1_kernel_g0_pp:
    s_waitcnt vmcnt(5)
    s_barrier
    s_waitcnt lgkmcnt(8)
    v_mfma_f32_16x16x32_bf16 v[208:211], v[8:11], v[128:131], v[208:211]
    v_mfma_f32_32x32x16_bf16 v[64:79], v[128:131], v[160:163], v[64:79]
    ds_read_b64_tr_b16 v[128:129], v28 offset:32768
    ds_read_b64_tr_b16 v[130:131], v28 offset:33024
    ds_read_b128 v[176:179], v44 offset:32768
    v_mfma_f32_32x32x16_bf16 v[64:79], v[132:135], v[164:167], v[64:79]
    ds_read_b64_tr_b16 v[132:133], v29 offset:32768
    ds_read_b64_tr_b16 v[134:135], v29 offset:33024
    ds_read_b128 v[180:183], v45 offset:32768
    s_lshl_b32 s60, s78, 7
    s_add_u32 s60, s60, s69
    s_mul_i32 s61, s78, 196608
    s_add_u32 s78, s78, 1
    s_and_b32 s78, s78, 7
    s_add_u32 m0, s70, 32768
    s_add_u32 s63, s60, 7168
    buffer_load_dwordx4 v48, s[24:27], s60 offen lds
    buffer_load_dwordx4 v49, s[24:27], s63 offen offset:1024 lds
    v_mfma_f32_32x32x16_bf16 v[64:79], v[136:139], v[168:171], v[64:79]
    ds_read_b64_tr_b16 v[136:137], v30 offset:32768
    ds_read_b64_tr_b16 v[138:139], v30 offset:33024
    ds_read_b128 v[184:187], v46 offset:32768
    v_mfma_f32_32x32x16_bf16 v[64:79], v[140:143], v[172:175], v[64:79]
    ds_read_b64_tr_b16 v[140:141], v31 offset:32768
    ds_read_b64_tr_b16 v[142:143], v31 offset:33024
    ds_read_b128 v[188:191], v47 offset:32768
    s_add_u32 m0, s75, 32768
    s_add_u32 s63, s61, s73
    buffer_load_dwordx4 v50, s[28:31], s63 offen lds
    s_waitcnt lgkmcnt(12)
    v_mfma_f32_16x16x32_bf16 v[212:215], v[8:11], v[144:147], v[212:215]
    v_mfma_f32_32x32x16_bf16 v[80:95], v[144:147], v[160:163], v[80:95]
    ds_read_b64_tr_b16 v[144:145], v28 offset:36864
    ds_read_b64_tr_b16 v[146:147], v28 offset:37120
    v_mfma_f32_32x32x16_bf16 v[80:95], v[148:151], v[164:167], v[80:95]
    ds_read_b64_tr_b16 v[148:149], v29 offset:36864
    ds_read_b64_tr_b16 v[150:151], v29 offset:37120
    v_mfma_f32_32x32x16_bf16 v[80:95], v[152:155], v[168:171], v[80:95]
    ds_read_b64_tr_b16 v[152:153], v30 offset:36864
    ds_read_b64_tr_b16 v[154:155], v30 offset:37120
    v_mfma_f32_32x32x16_bf16 v[80:95], v[156:159], v[172:175], v[80:95]
    ds_read_b64_tr_b16 v[156:157], v31 offset:36864
    ds_read_b64_tr_b16 v[158:159], v31 offset:37120
    s_add_u32 m0, s75, 36864
    s_add_u32 s63, s61, s74
    buffer_load_dwordx4 v50, s[28:31], s63 offen lds
    v_mfma_f32_32x32x16_bf16 v[192:207], v[160:163], v[160:163], v[192:207]
    v_mfma_f32_32x32x16_bf16 v[192:207], v[164:167], v[164:167], v[192:207]
    v_mfma_f32_32x32x16_bf16 v[192:207], v[168:171], v[168:171], v[192:207]
    v_mfma_f32_32x32x16_bf16 v[192:207], v[172:175], v[172:175], v[192:207]
    s_waitcnt vmcnt(5)
    s_barrier
    s_waitcnt lgkmcnt(8)
    v_mfma_f32_16x16x32_bf16 v[208:211], v[8:11], v[128:131], v[208:211]
    v_mfma_f32_32x32x16_bf16 v[64:79], v[128:131], v[176:179], v[64:79]
    ds_read_b64_tr_b16 v[128:129], v56 offset:0
    ds_read_b64_tr_b16 v[130:131], v56 offset:256
    ds_read_b128 v[160:163], v40 offset:0
    v_mfma_f32_32x32x16_bf16 v[64:79], v[132:135], v[180:183], v[64:79]
    ds_read_b64_tr_b16 v[132:133], v57 offset:0
    ds_read_b64_tr_b16 v[134:135], v57 offset:256
    ds_read_b128 v[164:167], v41 offset:0
    s_lshl_b32 s60, s78, 7
    s_add_u32 s60, s60, s69
    s_mul_i32 s61, s78, 196608
    s_add_u32 s78, s78, 1
    s_and_b32 s78, s78, 7
    s_add_u32 m0, s70, 65536
    s_add_u32 s63, s60, 7168
    buffer_load_dwordx4 v48, s[24:27], s60 offen lds
    buffer_load_dwordx4 v49, s[24:27], s63 offen offset:1024 lds
    v_mfma_f32_32x32x16_bf16 v[64:79], v[136:139], v[184:187], v[64:79]
    ds_read_b64_tr_b16 v[136:137], v58 offset:0
    ds_read_b64_tr_b16 v[138:139], v58 offset:256
    ds_read_b128 v[168:171], v42 offset:0
    v_mfma_f32_32x32x16_bf16 v[64:79], v[140:143], v[188:191], v[64:79]
    ds_read_b64_tr_b16 v[140:141], v59 offset:0
    ds_read_b64_tr_b16 v[142:143], v59 offset:256
    ds_read_b128 v[172:175], v43 offset:0
    s_add_u32 m0, s75, 65536
    s_add_u32 s63, s61, s73
    buffer_load_dwordx4 v50, s[28:31], s63 offen lds
    s_waitcnt lgkmcnt(12)
    v_mfma_f32_16x16x32_bf16 v[212:215], v[8:11], v[144:147], v[212:215]
    v_mfma_f32_32x32x16_bf16 v[80:95], v[144:147], v[176:179], v[80:95]
    ds_read_b64_tr_b16 v[144:145], v56 offset:4096
    ds_read_b64_tr_b16 v[146:147], v56 offset:4352
    v_mfma_f32_32x32x16_bf16 v[80:95], v[148:151], v[180:183], v[80:95]
    ds_read_b64_tr_b16 v[148:149], v57 offset:4096
    ds_read_b64_tr_b16 v[150:151], v57 offset:4352
    v_mfma_f32_32x32x16_bf16 v[80:95], v[152:155], v[184:187], v[80:95]
    ds_read_b64_tr_b16 v[152:153], v58 offset:4096
    ds_read_b64_tr_b16 v[154:155], v58 offset:4352
    v_mfma_f32_32x32x16_bf16 v[80:95], v[156:159], v[188:191], v[80:95]
    ds_read_b64_tr_b16 v[156:157], v59 offset:4096
    ds_read_b64_tr_b16 v[158:159], v59 offset:4352
    s_add_u32 m0, s75, 69632
    s_add_u32 s63, s61, s74
    buffer_load_dwordx4 v50, s[28:31], s63 offen lds
    v_mfma_f32_32x32x16_bf16 v[192:207], v[176:179], v[176:179], v[192:207]
    v_mfma_f32_32x32x16_bf16 v[192:207], v[180:183], v[180:183], v[192:207]
    v_mfma_f32_32x32x16_bf16 v[192:207], v[184:187], v[184:187], v[192:207]
    v_mfma_f32_32x32x16_bf16 v[192:207], v[188:191], v[188:191], v[192:207]
    s_nop 7
    s_lshl_b32 s60, s53, 7
    v_lshlrev_b32 v5, 2, v1
    v_add_u32 v5, s60, v5
    v_add_u32 v5, 133120, v5
    s_mov_b64 exec, 0xffff
    v_add_u32 v6, 0, v5
    ds_write2_b32 v6, v208, v209 offset0:0 offset1:16
    v_add_u32 v6, 512, v5
    ds_write2_b32 v6, v212, v213 offset0:0 offset1:16
    s_mov_b64 exec, -1
    s_nop 7
    v_and_b32 v5, 1, v1
    v_cmp_eq_u32 vcc, 1, v5
    v_and_b32 v5, 2, v1
    v_cmp_eq_u32 s[86:87], 2, v5
    v_and_b32 v5, 8, v1
    v_cmp_eq_u32 s[88:89], 8, v5
    v_and_b32 v5, 16, v1
    v_cmp_eq_u32 s[90:91], 16, v5
    v_cndmask_b32 v224, v192, v193, vcc
    v_cndmask_b32 v225, v194, v195, vcc
    v_cndmask_b32 v226, v196, v197, vcc
    v_cndmask_b32 v227, v198, v199, vcc
    v_cndmask_b32 v228, v200, v201, vcc
    v_cndmask_b32 v229, v202, v203, vcc
    v_cndmask_b32 v230, v204, v205, vcc
    v_cndmask_b32 v231, v206, v207, vcc
    v_cndmask_b32 v224, v224, v225, s[86:87]
    v_cndmask_b32 v225, v226, v227, s[86:87]
    v_cndmask_b32 v226, v228, v229, s[86:87]
    v_cndmask_b32 v227, v230, v231, s[86:87]
    v_cndmask_b32 v224, v224, v225, s[88:89]
    v_cndmask_b32 v225, v226, v227, s[88:89]
    v_cndmask_b32 v224, v224, v225, s[90:91]
    v_bfe_u32 v5, v1, 2, 1
    v_lshrrev_b32 v6, 5, v1
    v_cmp_eq_u32 vcc, v5, v6
    v_and_b32 v5, 31, v1
    v_lshlrev_b32 v5, 2, v5
    s_lshl_b32 s60, s53, 7
    s_add_u32 s60, s60, 132096
    v_add_u32 v5, s60, v5
    s_mov_b64 exec, vcc
    ds_write_b32 v5, v224
    s_mov_b64 exec, -1
    s_waitcnt vmcnt(4) lgkmcnt(0)
    s_barrier
    s_waitcnt lgkmcnt(8)
    v_mfma_f32_16x16x32_bf16 v[216:219], v[8:11], v[128:131], v[216:219]
    v_mfma_f32_32x32x16_bf16 v[96:111], v[128:131], v[160:163], v[96:111]
    ds_read_b64_tr_b16 v[128:129], v56 offset:32768
    ds_read_b64_tr_b16 v[130:131], v56 offset:33024
    ds_read_b128 v[176:179], v40 offset:32768
    v_mfma_f32_32x32x16_bf16 v[96:111], v[132:135], v[164:167], v[96:111]
    ds_read_b64_tr_b16 v[132:133], v57 offset:32768
    ds_read_b64_tr_b16 v[134:135], v57 offset:33024
    ds_read_b128 v[180:183], v41 offset:32768
    s_lshl_b32 s60, s78, 7
    s_add_u32 s60, s60, s69
    s_mul_i32 s61, s78, 196608
    s_add_u32 s78, s78, 1
    s_and_b32 s78, s78, 7
    s_add_u32 m0, s70, 98304
    s_add_u32 s63, s60, 7168
    buffer_load_dwordx4 v48, s[24:27], s60 offen lds
    buffer_load_dwordx4 v49, s[24:27], s63 offen offset:1024 lds
    v_mfma_f32_32x32x16_bf16 v[96:111], v[136:139], v[168:171], v[96:111]
    ds_read_b64_tr_b16 v[136:137], v58 offset:32768
    ds_read_b64_tr_b16 v[138:139], v58 offset:33024
    ds_read_b128 v[184:187], v42 offset:32768
    v_mfma_f32_32x32x16_bf16 v[96:111], v[140:143], v[172:175], v[96:111]
    ds_read_b64_tr_b16 v[140:141], v59 offset:32768
    ds_read_b64_tr_b16 v[142:143], v59 offset:33024
    ds_read_b128 v[188:191], v43 offset:32768
    s_add_u32 m0, s75, 98304
    s_add_u32 s63, s61, s73
    buffer_load_dwordx4 v50, s[28:31], s63 offen lds
    s_waitcnt lgkmcnt(12)
    v_mfma_f32_16x16x32_bf16 v[220:223], v[8:11], v[144:147], v[220:223]
    v_mfma_f32_32x32x16_bf16 v[112:127], v[144:147], v[160:163], v[112:127]
    ds_read_b64_tr_b16 v[144:145], v56 offset:36864
    ds_read_b64_tr_b16 v[146:147], v56 offset:37120
    v_mfma_f32_32x32x16_bf16 v[112:127], v[148:151], v[164:167], v[112:127]
    ds_read_b64_tr_b16 v[148:149], v57 offset:36864
    ds_read_b64_tr_b16 v[150:151], v57 offset:37120
    v_mfma_f32_32x32x16_bf16 v[112:127], v[152:155], v[168:171], v[112:127]
    ds_read_b64_tr_b16 v[152:153], v58 offset:36864
    ds_read_b64_tr_b16 v[154:155], v58 offset:37120
    v_mfma_f32_32x32x16_bf16 v[112:127], v[156:159], v[172:175], v[112:127]
    ds_read_b64_tr_b16 v[156:157], v59 offset:36864
    ds_read_b64_tr_b16 v[158:159], v59 offset:37120
    s_add_u32 m0, s75, 102400
    s_add_u32 s63, s61, s74
    buffer_load_dwordx4 v50, s[28:31], s63 offen lds
    v_and_b32 v5, 31, v1
    v_lshlrev_b32 v5, 2, v5
    s_lshl_b32 s60, s53, 7
    s_add_u32 s60, s60, 131584
    v_add_u32 v5, s60, v5
    ds_read2_b32 v[224:225], v5 offset0:0 offset1:128
    s_waitcnt lgkmcnt(0)
    v_mul_f32 v224, 0x3b000000, v224
    v_mul_f32 v228, 0x3b000000, v225
    v_fma_f32 v228, -v224, v224, v228
    v_max_f32 v228, 0, v228
    v_add_f32 v228, 0x3727c5ac, v228
    v_rsq_f32 v60, v228
    v_sqrt_f32 v229, v228
    v_sub_f32 v224, 0, v224
    v_cvt_pk_bf16_f32 v12, v224, v224
    v_and_b32 v225, 0xffff0000, v12
    v_sub_f32 v225, v224, v225
    v_cvt_pk_bf16_f32 v13, v225, v225
    v_cvt_pk_bf16_f32 v226, v229, v229
    v_and_b32 v226, 0xffff0000, v226
    v_sub_f32 v226, v229, v226
    v_cvt_pk_bf16_f32 v14, v229, v226
    v_mov_b32 v15, 0
    v_cmp_gt_u32 vcc, 32, v1
    v_subrev_u32 v5, 512, v5
    s_nop 0
    v_cndmask_b32 v12, 0, v12, vcc
    v_cndmask_b32 v13, 0, v13, vcc
    v_cndmask_b32 v14, 0, v14, vcc
    v_mul_f32 v32, 0x3fb8aa3b, v60
    v_mul_f32 v34, -2.0, v60
    v_mov_b32 v36, v60
    v_mul_f32 v38, 0x3eb8aa3b, v60
    v_and_b32 v5, 31, v1
    v_lshlrev_b32 v5, 2, v5
    v_add_u32 v6, 133120, v5
    ds_read2_b32 v[232:233], v6 offset0:0 offset1:32
    ds_read2_b32 v[234:235], v6 offset0:64 offset1:96
    s_waitcnt lgkmcnt(0)
    v_add_f32 v232, v232, v233
    v_add_f32 v234, v234, v235
    v_add_f32 v232, v232, v234
    v_cvt_pk_bf16_f32 v233, v232, v232
    v_and_b32 v233, 0xffff0000, v233
    v_sub_f32 v233, v232, v233
    v_cvt_pk_bf16_f32 v16, v232, v233
    v_mov_b32 v17, v16
    v_lshl_or_b32 v18, v61, 16, v61
    v_mov_b32 v19, 0
    s_nop 1
    v_mfma_f32_32x32x16_bf16 v[64:79], v[16:19], v[12:15], v[64:79]
    v_and_b32 v5, 31, v1
    v_lshlrev_b32 v5, 2, v5
    v_add_u32 v6, 133632, v5
    ds_read2_b32 v[232:233], v6 offset0:0 offset1:32
    ds_read2_b32 v[234:235], v6 offset0:64 offset1:96
    s_waitcnt lgkmcnt(0)
    v_add_f32 v232, v232, v233
    v_add_f32 v234, v234, v235
    v_add_f32 v232, v232, v234
    v_cvt_pk_bf16_f32 v233, v232, v232
    v_and_b32 v233, 0xffff0000, v233
    v_sub_f32 v233, v232, v233
    v_cvt_pk_bf16_f32 v16, v232, v233
    v_mov_b32 v17, v16
    v_lshl_or_b32 v18, v62, 16, v62
    v_mov_b32 v19, 0
    s_nop 1
    v_mfma_f32_32x32x16_bf16 v[80:95], v[16:19], v[12:15], v[80:95]
    s_waitcnt vmcnt(4)
    s_barrier
    s_waitcnt lgkmcnt(8)
    v_mfma_f32_16x16x32_bf16 v[216:219], v[8:11], v[128:131], v[216:219]
    v_mul_f32 v224, v64, v32
    v_exp_f32 v224, v224
    v_mul_f32 v225, v65, v32
    v_mfma_f32_32x32x16_bf16 v[96:111], v[128:131], v[176:179], v[96:111]
    v_exp_f32 v225, v225
    v_mul_f32 v226, v66, v32
    v_add_f32 v232, 2.0, v224
    v_exp_f32 v226, v226
    ds_read_b64_tr_b16 v[128:129], v28 offset:0
    ds_read_b64_tr_b16 v[130:131], v28 offset:256
    ds_read_b128 v[160:163], v44 offset:0
    v_mfma_f32_32x32x16_bf16 v[96:111], v[132:135], v[180:183], v[96:111]
    v_mul_f32 v227, v67, v32
    v_fma_f32 v232, v224, v232, 2.0
    v_add_f32 v233, 2.0, v225
    v_exp_f32 v227, v227
    ds_read_b64_tr_b16 v[132:133], v29 offset:0
    ds_read_b64_tr_b16 v[134:135], v29 offset:256
    ds_read_b128 v[164:167], v45 offset:0
    s_lshl_b32 s60, s78, 7
    s_add_u32 s60, s60, s69
    s_mul_i32 s61, s78, 196608
    s_add_u32 s78, s78, 1
    s_and_b32 s78, s78, 7
    s_add_u32 m0, s70, 0
    s_add_u32 s63, s60, 7168
    buffer_load_dwordx4 v48, s[24:27], s60 offen lds
    buffer_load_dwordx4 v49, s[24:27], s63 offen offset:1024 lds
    v_mfma_f32_32x32x16_bf16 v[96:111], v[136:139], v[184:187], v[96:111]
    v_mul_f32 v228, v68, v32
    v_rcp_f32 v232, v232
    v_fma_f32 v233, v225, v233, 2.0
    ds_read_b64_tr_b16 v[136:137], v30 offset:0
    ds_read_b64_tr_b16 v[138:139], v30 offset:256
    ds_read_b128 v[168:171], v46 offset:0
    v_mfma_f32_32x32x16_bf16 v[96:111], v[140:143], v[188:191], v[96:111]
    v_add_f32 v234, 2.0, v226
    v_exp_f32 v228, v228
    v_mul_f32 v229, v69, v32
    v_rcp_f32 v233, v233
    ds_read_b64_tr_b16 v[140:141], v31 offset:0
    ds_read_b64_tr_b16 v[142:143], v31 offset:256
    ds_read_b128 v[172:175], v47 offset:0
    s_add_u32 m0, s75, 0
    s_add_u32 s63, s61, s73
    buffer_load_dwordx4 v50, s[28:31], s63 offen lds
    s_waitcnt lgkmcnt(12)
    v_mfma_f32_16x16x32_bf16 v[220:223], v[8:11], v[144:147], v[220:223]
    v_fma_f32 v234, v226, v234, 2.0
    v_add_f32 v235, 2.0, v227
    v_exp_f32 v229, v229
    v_mul_f32 v230, v70, v32
    v_mfma_f32_32x32x16_bf16 v[112:127], v[144:147], v[176:179], v[112:127]
    v_fma_f32 v232, v232, v34, v60
    v_rcp_f32 v234, v234
    v_fma_f32 v235, v227, v235, 2.0
    ds_read_b64_tr_b16 v[144:145], v28 offset:4096
    ds_read_b64_tr_b16 v[146:147], v28 offset:4352
    v_mfma_f32_32x32x16_bf16 v[112:127], v[148:151], v[180:183], v[112:127]
    v_add_f32 v236, 2.0, v228
    v_exp_f32 v230, v230
    v_mul_f32 v231, v71, v32
    v_mul_f32 v64, v64, v232
    ds_read_b64_tr_b16 v[148:149], v29 offset:4096
    ds_read_b64_tr_b16 v[150:151], v29 offset:4352
    v_mfma_f32_32x32x16_bf16 v[112:127], v[152:155], v[184:187], v[112:127]
    v_fma_f32 v233, v233, v34, v60
    v_rcp_f32 v235, v235
    v_fma_f32 v236, v228, v236, 2.0
    v_add_f32 v237, 2.0, v229
    ds_read_b64_tr_b16 v[152:153], v30 offset:4096
    ds_read_b64_tr_b16 v[154:155], v30 offset:4352
    v_mfma_f32_32x32x16_bf16 v[112:127], v[156:159], v[188:191], v[112:127]
    v_exp_f32 v231, v231
    v_mul_f32 v224, v72, v32
    v_mul_f32 v65, v65, v233
    v_fma_f32 v234, v234, v34, v60
    ds_read_b64_tr_b16 v[156:157], v31 offset:4096
    ds_read_b64_tr_b16 v[158:159], v31 offset:4352
    s_add_u32 m0, s75, 4096
    s_add_u32 s63, s61, s74
    buffer_load_dwordx4 v50, s[28:31], s63 offen lds
    s_waitcnt vmcnt(4)
    s_barrier
    s_waitcnt lgkmcnt(8)
    v_mfma_f32_16x16x32_bf16 v[216:219], v[8:11], v[128:131], v[216:219]
    v_rcp_f32 v236, v236
    v_fma_f32 v237, v229, v237, 2.0
    v_add_f32 v238, 2.0, v230
    v_mfma_f32_32x32x16_bf16 v[96:111], v[128:131], v[160:163], v[96:111]
    v_exp_f32 v224, v224
    v_mul_f32 v225, v73, v32
    v_cvt_pk_bf16_f32 v240, v64, v65
    v_mul_f32 v66, v66, v234
    ds_read_b64_tr_b16 v[128:129], v28 offset:32768
    ds_read_b64_tr_b16 v[130:131], v28 offset:33024
    ds_read_b128 v[176:179], v44 offset:32768
    v_mfma_f32_32x32x16_bf16 v[96:111], v[132:135], v[164:167], v[96:111]
    v_fma_f32 v235, v235, v34, v60
    v_rcp_f32 v237, v237
    v_fma_f32 v238, v230, v238, 2.0
    v_add_f32 v239, 2.0, v231
    ds_read_b64_tr_b16 v[132:133], v29 offset:32768
    ds_read_b64_tr_b16 v[134:135], v29 offset:33024
    ds_read_b128 v[180:183], v45 offset:32768
    s_lshl_b32 s60, s78, 7
    s_add_u32 s60, s60, s69
    s_mul_i32 s61, s78, 196608
    s_add_u32 s78, s78, 1
    s_and_b32 s78, s78, 7
    s_add_u32 m0, s70, 32768
    s_add_u32 s63, s60, 7168
    buffer_load_dwordx4 v48, s[24:27], s60 offen lds
    buffer_load_dwordx4 v49, s[24:27], s63 offen offset:1024 lds
    v_mfma_f32_32x32x16_bf16 v[96:111], v[136:139], v[168:171], v[96:111]
    v_exp_f32 v225, v225
    v_mul_f32 v226, v74, v32
    v_mul_f32 v67, v67, v235
    ds_read_b64_tr_b16 v[136:137], v30 offset:32768
    ds_read_b64_tr_b16 v[138:139], v30 offset:33024
    ds_read_b128 v[184:187], v46 offset:32768
    v_mfma_f32_32x32x16_bf16 v[96:111], v[140:143], v[172:175], v[96:111]
    v_fma_f32 v236, v236, v34, v60
    v_rcp_f32 v238, v238
    v_fma_f32 v239, v231, v239, 2.0
    v_add_f32 v232, 2.0, v224
    ds_read_b64_tr_b16 v[140:141], v31 offset:32768
    ds_read_b64_tr_b16 v[142:143], v31 offset:33024
    ds_read_b128 v[188:191], v47 offset:32768
    s_add_u32 m0, s75, 32768
    s_add_u32 s63, s61, s73
    buffer_load_dwordx4 v50, s[28:31], s63 offen lds
    s_waitcnt lgkmcnt(12)
    v_mfma_f32_16x16x32_bf16 v[220:223], v[8:11], v[144:147], v[220:223]
    v_exp_f32 v226, v226
    v_mul_f32 v227, v75, v32
    v_cvt_pk_bf16_f32 v241, v66, v67
    v_mul_f32 v68, v68, v236
    v_mfma_f32_32x32x16_bf16 v[112:127], v[144:147], v[160:163], v[112:127]
    v_fma_f32 v237, v237, v34, v60
    v_rcp_f32 v239, v239
    v_fma_f32 v232, v224, v232, 2.0
    ds_read_b64_tr_b16 v[144:145], v28 offset:36864
    ds_read_b64_tr_b16 v[146:147], v28 offset:37120
    v_mfma_f32_32x32x16_bf16 v[112:127], v[148:151], v[164:167], v[112:127]
    v_add_f32 v233, 2.0, v225
    v_exp_f32 v227, v227
    v_mul_f32 v228, v76, v32
    v_mul_f32 v69, v69, v237
    ds_read_b64_tr_b16 v[148:149], v29 offset:36864
    ds_read_b64_tr_b16 v[150:151], v29 offset:37120
    v_mfma_f32_32x32x16_bf16 v[112:127], v[152:155], v[168:171], v[112:127]
    v_fma_f32 v238, v238, v34, v60
    v_rcp_f32 v232, v232
    v_fma_f32 v233, v225, v233, 2.0
    v_add_f32 v234, 2.0, v226
    ds_read_b64_tr_b16 v[152:153], v30 offset:36864
    ds_read_b64_tr_b16 v[154:155], v30 offset:37120
    v_mfma_f32_32x32x16_bf16 v[112:127], v[156:159], v[172:175], v[112:127]
    v_exp_f32 v228, v228
    v_mul_f32 v229, v77, v32
    v_cvt_pk_bf16_f32 v242, v68, v69
    v_mul_f32 v70, v70, v238
    ds_read_b64_tr_b16 v[156:157], v31 offset:36864
    ds_read_b64_tr_b16 v[158:159], v31 offset:37120
    s_add_u32 m0, s75, 36864
    s_add_u32 s63, s61, s74
    buffer_load_dwordx4 v50, s[28:31], s63 offen lds
    s_waitcnt vmcnt(4)
    s_barrier
    s_waitcnt lgkmcnt(8)
    v_mfma_f32_16x16x32_bf16 v[216:219], v[8:11], v[128:131], v[216:219]
    v_fma_f32 v239, v239, v34, v60
    v_rcp_f32 v233, v233
    v_fma_f32 v234, v226, v234, 2.0
    v_mfma_f32_32x32x16_bf16 v[96:111], v[128:131], v[176:179], v[96:111]
    v_add_f32 v235, 2.0, v227
    v_exp_f32 v229, v229
    v_mul_f32 v230, v78, v32
    v_mul_f32 v71, v71, v239
    ds_read_b64_tr_b16 v[128:129], v56 offset:0
    ds_read_b64_tr_b16 v[130:131], v56 offset:256
    ds_read_b128 v[160:163], v40 offset:0
    v_mfma_f32_32x32x16_bf16 v[96:111], v[132:135], v[180:183], v[96:111]
    v_fma_f32 v232, v232, v34, v60
    v_rcp_f32 v234, v234
    v_fma_f32 v235, v227, v235, 2.0
    v_add_f32 v236, 2.0, v228
    ds_read_b64_tr_b16 v[132:133], v57 offset:0
    ds_read_b64_tr_b16 v[134:135], v57 offset:256
    ds_read_b128 v[164:167], v41 offset:0
    s_lshl_b32 s60, s78, 7
    s_add_u32 s60, s60, s69
    s_mul_i32 s61, s78, 196608
    s_add_u32 s78, s78, 1
    s_and_b32 s78, s78, 7
    s_add_u32 m0, s70, 65536
    s_add_u32 s63, s60, 7168
    buffer_load_dwordx4 v48, s[24:27], s60 offen lds
    buffer_load_dwordx4 v49, s[24:27], s63 offen offset:1024 lds
    v_mfma_f32_32x32x16_bf16 v[96:111], v[136:139], v[184:187], v[96:111]
    v_exp_f32 v230, v230
    v_mul_f32 v231, v79, v32
    v_cvt_pk_bf16_f32 v243, v70, v71
    ds_read_b64_tr_b16 v[136:137], v58 offset:0
    ds_read_b64_tr_b16 v[138:139], v58 offset:256
    ds_read_b128 v[168:171], v42 offset:0
    v_mfma_f32_32x32x16_bf16 v[96:111], v[140:143], v[188:191], v[96:111]
    v_mul_f32 v72, v72, v232
    v_fma_f32 v233, v233, v34, v60
    v_rcp_f32 v235, v235
    v_fma_f32 v236, v228, v236, 2.0
    ds_read_b64_tr_b16 v[140:141], v59 offset:0
    ds_read_b64_tr_b16 v[142:143], v59 offset:256
    ds_read_b128 v[172:175], v43 offset:0
    s_add_u32 m0, s75, 65536
    s_add_u32 s63, s61, s73
    buffer_load_dwordx4 v50, s[28:31], s63 offen lds
    s_waitcnt lgkmcnt(12)
    v_mfma_f32_16x16x32_bf16 v[220:223], v[8:11], v[144:147], v[220:223]
    v_add_f32 v237, 2.0, v229
    v_exp_f32 v231, v231
    v_mul_f32 v73, v73, v233
    v_fma_f32 v234, v234, v34, v60
    v_mfma_f32_32x32x16_bf16 v[112:127], v[144:147], v[176:179], v[112:127]
    v_rcp_f32 v236, v236
    v_fma_f32 v237, v229, v237, 2.0
    v_add_f32 v238, 2.0, v230
    ds_read_b64_tr_b16 v[144:145], v56 offset:4096
    ds_read_b64_tr_b16 v[146:147], v56 offset:4352
    v_mfma_f32_32x32x16_bf16 v[112:127], v[148:151], v[180:183], v[112:127]
    v_cvt_pk_bf16_f32 v244, v72, v73
    v_mul_f32 v74, v74, v234
    v_fma_f32 v235, v235, v34, v60
    v_rcp_f32 v237, v237
    ds_read_b64_tr_b16 v[148:149], v57 offset:4096
    ds_read_b64_tr_b16 v[150:151], v57 offset:4352
    v_mfma_f32_32x32x16_bf16 v[112:127], v[152:155], v[184:187], v[112:127]
    v_fma_f32 v238, v230, v238, 2.0
    v_add_f32 v239, 2.0, v231
    v_mul_f32 v75, v75, v235
    v_fma_f32 v236, v236, v34, v60
    ds_read_b64_tr_b16 v[152:153], v58 offset:4096
    ds_read_b64_tr_b16 v[154:155], v58 offset:4352
    v_mfma_f32_32x32x16_bf16 v[112:127], v[156:159], v[188:191], v[112:127]
    v_rcp_f32 v238, v238
    v_fma_f32 v239, v231, v239, 2.0
    v_cvt_pk_bf16_f32 v245, v74, v75
    v_mul_f32 v76, v76, v236
    ds_read_b64_tr_b16 v[156:157], v59 offset:4096
    ds_read_b64_tr_b16 v[158:159], v59 offset:4352
    s_add_u32 m0, s75, 69632
    s_add_u32 s63, s61, s74
    buffer_load_dwordx4 v50, s[28:31], s63 offen lds
    s_waitcnt vmcnt(4)
    s_barrier
    s_waitcnt lgkmcnt(8)
    v_mfma_f32_16x16x32_bf16 v[216:219], v[8:11], v[128:131], v[216:219]
    v_fma_f32 v237, v237, v34, v60
    v_rcp_f32 v239, v239
    v_mul_f32 v77, v77, v237
    v_mfma_f32_32x32x16_bf16 v[96:111], v[128:131], v[160:163], v[96:111]
    v_fma_f32 v238, v238, v34, v60
    v_cvt_pk_bf16_f32 v246, v76, v77
    v_mul_f32 v78, v78, v238
    v_fma_f32 v239, v239, v34, v60
    ds_read_b64_tr_b16 v[128:129], v56 offset:32768
    ds_read_b64_tr_b16 v[130:131], v56 offset:33024
    ds_read_b128 v[176:179], v40 offset:32768
    v_mfma_f32_32x32x16_bf16 v[96:111], v[132:135], v[164:167], v[96:111]
    v_mul_f32 v79, v79, v239
    v_cvt_pk_bf16_f32 v247, v78, v79
    s_mul_i32 s67, s58, 112
    s_add_u32 s68, s57, 0
    ds_read_b64_tr_b16 v[132:133], v57 offset:32768
    ds_read_b64_tr_b16 v[134:135], v57 offset:33024
    ds_read_b128 v[180:183], v41 offset:32768
    s_lshl_b32 s60, s78, 7
    s_add_u32 s60, s60, s69
    s_mul_i32 s61, s78, 196608
    s_add_u32 s78, s78, 1
    s_and_b32 s78, s78, 7
    s_add_u32 m0, s70, 98304
    s_add_u32 s63, s60, 7168
    buffer_load_dwordx4 v48, s[24:27], s60 offen lds
    buffer_load_dwordx4 v49, s[24:27], s63 offen offset:1024 lds
    v_mfma_f32_32x32x16_bf16 v[96:111], v[136:139], v[168:171], v[96:111]
    s_lshl_b32 s68, s68, 1
    s_add_u32 s67, s67, s68
    s_lshl_b32 s67, s67, 10
    ds_read_b64_tr_b16 v[136:137], v58 offset:32768
    ds_read_b64_tr_b16 v[138:139], v58 offset:33024
    ds_read_b128 v[184:187], v42 offset:32768
    v_mfma_f32_32x32x16_bf16 v[96:111], v[140:143], v[172:175], v[96:111]
    s_add_u32 s67, s67, 8388608
    buffer_store_dwordx4 v[240:243], v2, s[36:39], s67 offen sc1
    buffer_store_dwordx4 v[244:247], v2, s[36:39], s67 offen offset:1024 sc1
    v_mul_f32 v224, v80, v32
    ds_read_b64_tr_b16 v[140:141], v59 offset:32768
    ds_read_b64_tr_b16 v[142:143], v59 offset:33024
    ds_read_b128 v[188:191], v43 offset:32768
    s_add_u32 m0, s75, 98304
    s_add_u32 s63, s61, s73
    buffer_load_dwordx4 v50, s[28:31], s63 offen lds
    s_waitcnt lgkmcnt(12)
    v_mfma_f32_16x16x32_bf16 v[220:223], v[8:11], v[144:147], v[220:223]
    v_exp_f32 v224, v224
    v_mul_f32 v225, v81, v32
    v_exp_f32 v225, v225
    v_mul_f32 v226, v82, v32
    v_mfma_f32_32x32x16_bf16 v[112:127], v[144:147], v[160:163], v[112:127]
    v_add_f32 v232, 2.0, v224
    v_exp_f32 v226, v226
    v_mul_f32 v227, v83, v32
    ds_read_b64_tr_b16 v[144:145], v56 offset:36864
    ds_read_b64_tr_b16 v[146:147], v56 offset:37120
    v_mfma_f32_32x32x16_bf16 v[112:127], v[148:151], v[164:167], v[112:127]
    v_fma_f32 v232, v224, v232, 2.0
    v_add_f32 v233, 2.0, v225
    v_exp_f32 v227, v227
    v_mul_f32 v228, v84, v32
    ds_read_b64_tr_b16 v[148:149], v57 offset:36864
    ds_read_b64_tr_b16 v[150:151], v57 offset:37120
    v_mfma_f32_32x32x16_bf16 v[112:127], v[152:155], v[168:171], v[112:127]
    v_rcp_f32 v232, v232
    v_fma_f32 v233, v225, v233, 2.0
    v_add_f32 v234, 2.0, v226
    v_exp_f32 v228, v228
    ds_read_b64_tr_b16 v[152:153], v58 offset:36864
    ds_read_b64_tr_b16 v[154:155], v58 offset:37120
    v_mfma_f32_32x32x16_bf16 v[112:127], v[156:159], v[172:175], v[112:127]
    v_mul_f32 v229, v85, v32
    v_rcp_f32 v233, v233
    v_fma_f32 v234, v226, v234, 2.0
    v_add_f32 v235, 2.0, v227
    ds_read_b64_tr_b16 v[156:157], v59 offset:36864
    ds_read_b64_tr_b16 v[158:159], v59 offset:37120
    s_add_u32 m0, s75, 102400
    s_add_u32 s63, s61, s74
    buffer_load_dwordx4 v50, s[28:31], s63 offen lds
    s_waitcnt vmcnt(6)
    s_barrier
    s_waitcnt lgkmcnt(8)
    v_mfma_f32_16x16x32_bf16 v[216:219], v[8:11], v[128:131], v[216:219]
    v_exp_f32 v229, v229
    v_mul_f32 v230, v86, v32
    v_fma_f32 v232, v232, v34, v60
    v_mfma_f32_32x32x16_bf16 v[96:111], v[128:131], v[176:179], v[96:111]
    v_rcp_f32 v234, v234
    v_fma_f32 v235, v227, v235, 2.0
    v_add_f32 v236, 2.0, v228
    v_exp_f32 v230, v230
    ds_read_b64_tr_b16 v[128:129], v28 offset:0
    ds_read_b64_tr_b16 v[130:131], v28 offset:256
    ds_read_b128 v[160:163], v44 offset:0
    v_mfma_f32_32x32x16_bf16 v[96:111], v[132:135], v[180:183], v[96:111]
    v_mul_f32 v231, v87, v32
    v_mul_f32 v80, v80, v232
    v_fma_f32 v233, v233, v34, v60
    v_rcp_f32 v235, v235
    ds_read_b64_tr_b16 v[132:133], v29 offset:0
    ds_read_b64_tr_b16 v[134:135], v29 offset:256
    ds_read_b128 v[164:167], v45 offset:0
    v_mfma_f32_32x32x16_bf16 v[96:111], v[136:139], v[184:187], v[96:111]
    v_fma_f32 v236, v228, v236, 2.0
    v_add_f32 v237, 2.0, v229
    v_exp_f32 v231, v231
    ds_read_b64_tr_b16 v[136:137], v30 offset:0
    ds_read_b64_tr_b16 v[138:139], v30 offset:256
    ds_read_b128 v[168:171], v46 offset:0
    v_mfma_f32_32x32x16_bf16 v[96:111], v[140:143], v[188:191], v[96:111]
    v_mul_f32 v224, v88, v32
    v_mul_f32 v81, v81, v233
    v_fma_f32 v234, v234, v34, v60
    v_rcp_f32 v236, v236
    ds_read_b64_tr_b16 v[140:141], v31 offset:0
    ds_read_b64_tr_b16 v[142:143], v31 offset:256
    ds_read_b128 v[172:175], v47 offset:0
    s_waitcnt lgkmcnt(12)
    v_mfma_f32_16x16x32_bf16 v[220:223], v[8:11], v[144:147], v[220:223]
    v_fma_f32 v237, v229, v237, 2.0
    v_add_f32 v238, 2.0, v230
    v_exp_f32 v224, v224
    v_mul_f32 v225, v89, v32
    v_mfma_f32_32x32x16_bf16 v[112:127], v[144:147], v[176:179], v[112:127]
    v_cvt_pk_bf16_f32 v248, v80, v81
    v_mul_f32 v82, v82, v234
    v_fma_f32 v235, v235, v34, v60
    ds_read_b64_tr_b16 v[144:145], v28 offset:4096
    ds_read_b64_tr_b16 v[146:147], v28 offset:4352
    v_mfma_f32_32x32x16_bf16 v[112:127], v[148:151], v[180:183], v[112:127]
    v_rcp_f32 v237, v237
    v_fma_f32 v238, v230, v238, 2.0
    v_add_f32 v239, 2.0, v231
    v_exp_f32 v225, v225
    ds_read_b64_tr_b16 v[148:149], v29 offset:4096
    ds_read_b64_tr_b16 v[150:151], v29 offset:4352
    v_mfma_f32_32x32x16_bf16 v[112:127], v[152:155], v[184:187], v[112:127]
    v_mul_f32 v226, v90, v32
    v_mul_f32 v83, v83, v235
    v_fma_f32 v236, v236, v34, v60
    v_rcp_f32 v238, v238
    ds_read_b64_tr_b16 v[152:153], v30 offset:4096
    ds_read_b64_tr_b16 v[154:155], v30 offset:4352
    v_mfma_f32_32x32x16_bf16 v[112:127], v[156:159], v[188:191], v[112:127]
    v_fma_f32 v239, v231, v239, 2.0
    v_add_f32 v232, 2.0, v224
    v_exp_f32 v226, v226
    v_mul_f32 v227, v91, v32
    ds_read_b64_tr_b16 v[156:157], v31 offset:4096
    ds_read_b64_tr_b16 v[158:159], v31 offset:4352
    s_waitcnt vmcnt(0)
    s_barrier
    s_waitcnt lgkmcnt(8)
    v_mfma_f32_16x16x32_bf16 v[216:219], v[8:11], v[128:131], v[216:219]
    v_cvt_pk_bf16_f32 v249, v82, v83
    v_mul_f32 v84, v84, v236
    v_fma_f32 v237, v237, v34, v60
    v_mfma_f32_32x32x16_bf16 v[96:111], v[128:131], v[160:163], v[96:111]
    v_rcp_f32 v239, v239
    v_fma_f32 v232, v224, v232, 2.0
    v_add_f32 v233, 2.0, v225
    v_exp_f32 v227, v227
    ds_read_b64_tr_b16 v[128:129], v28 offset:32768
    ds_read_b64_tr_b16 v[130:131], v28 offset:33024
    ds_read_b128 v[176:179], v44 offset:32768
    v_mfma_f32_32x32x16_bf16 v[96:111], v[132:135], v[164:167], v[96:111]
    v_mul_f32 v228, v92, v32
    v_mul_f32 v85, v85, v237
    v_fma_f32 v238, v238, v34, v60
    v_rcp_f32 v232, v232
    ds_read_b64_tr_b16 v[132:133], v29 offset:32768
    ds_read_b64_tr_b16 v[134:135], v29 offset:33024
    ds_read_b128 v[180:183], v45 offset:32768
    v_mfma_f32_32x32x16_bf16 v[96:111], v[136:139], v[168:171], v[96:111]
    v_fma_f32 v233, v225, v233, 2.0
    v_add_f32 v234, 2.0, v226
    v_exp_f32 v228, v228
    ds_read_b64_tr_b16 v[136:137], v30 offset:32768
    ds_read_b64_tr_b16 v[138:139], v30 offset:33024
    ds_read_b128 v[184:187], v46 offset:32768
    v_mfma_f32_32x32x16_bf16 v[96:111], v[140:143], v[172:175], v[96:111]
    v_mul_f32 v229, v93, v32
    v_cvt_pk_bf16_f32 v250, v84, v85
    v_mul_f32 v86, v86, v238
    v_fma_f32 v239, v239, v34, v60
    ds_read_b64_tr_b16 v[140:141], v31 offset:32768
    ds_read_b64_tr_b16 v[142:143], v31 offset:33024
    ds_read_b128 v[188:191], v47 offset:32768
    s_waitcnt lgkmcnt(12)
    v_mfma_f32_16x16x32_bf16 v[220:223], v[8:11], v[144:147], v[220:223]
    v_rcp_f32 v233, v233
    v_fma_f32 v234, v226, v234, 2.0
    v_add_f32 v235, 2.0, v227
    v_exp_f32 v229, v229
    v_mfma_f32_32x32x16_bf16 v[112:127], v[144:147], v[160:163], v[112:127]
    v_mul_f32 v230, v94, v32
    v_mul_f32 v87, v87, v239
    v_fma_f32 v232, v232, v34, v60
    ds_read_b64_tr_b16 v[144:145], v28 offset:36864
    ds_read_b64_tr_b16 v[146:147], v28 offset:37120
    v_mfma_f32_32x32x16_bf16 v[112:127], v[148:151], v[164:167], v[112:127]
    v_rcp_f32 v234, v234
    v_fma_f32 v235, v227, v235, 2.0
    v_add_f32 v236, 2.0, v228
    v_exp_f32 v230, v230
    ds_read_b64_tr_b16 v[148:149], v29 offset:36864
    ds_read_b64_tr_b16 v[150:151], v29 offset:37120
    v_mfma_f32_32x32x16_bf16 v[112:127], v[152:155], v[168:171], v[112:127]
    v_mul_f32 v231, v95, v32
    v_cvt_pk_bf16_f32 v251, v86, v87
    v_mul_f32 v88, v88, v232
    v_fma_f32 v233, v233, v34, v60
    ds_read_b64_tr_b16 v[152:153], v30 offset:36864
    ds_read_b64_tr_b16 v[154:155], v30 offset:37120
    v_mfma_f32_32x32x16_bf16 v[112:127], v[156:159], v[172:175], v[112:127]
    v_rcp_f32 v235, v235
    v_fma_f32 v236, v228, v236, 2.0
    v_add_f32 v237, 2.0, v229
    v_exp_f32 v231, v231
    ds_read_b64_tr_b16 v[156:157], v31 offset:36864
    ds_read_b64_tr_b16 v[158:159], v31 offset:37120
    s_waitcnt lgkmcnt(8)
    v_mfma_f32_16x16x32_bf16 v[216:219], v[8:11], v[128:131], v[216:219]
    v_mul_f32 v89, v89, v233
    v_fma_f32 v234, v234, v34, v60
    v_rcp_f32 v236, v236
    v_mfma_f32_32x32x16_bf16 v[96:111], v[128:131], v[176:179], v[96:111]
    v_fma_f32 v237, v229, v237, 2.0
    v_add_f32 v238, 2.0, v230
    v_cvt_pk_bf16_f32 v252, v88, v89
    v_mfma_f32_32x32x16_bf16 v[96:111], v[132:135], v[180:183], v[96:111]
    v_mul_f32 v90, v90, v234
    v_fma_f32 v235, v235, v34, v60
    v_rcp_f32 v237, v237
    v_fma_f32 v238, v230, v238, 2.0
    v_mfma_f32_32x32x16_bf16 v[96:111], v[136:139], v[184:187], v[96:111]
    v_add_f32 v239, 2.0, v231
    v_mul_f32 v91, v91, v235
    v_fma_f32 v236, v236, v34, v60
    v_mfma_f32_32x32x16_bf16 v[96:111], v[140:143], v[188:191], v[96:111]
    v_rcp_f32 v238, v238
    v_fma_f32 v239, v231, v239, 2.0
    v_cvt_pk_bf16_f32 v253, v90, v91
    v_mul_f32 v92, v92, v236
    s_waitcnt lgkmcnt(0)
    v_mfma_f32_16x16x32_bf16 v[220:223], v[8:11], v[144:147], v[220:223]
    v_fma_f32 v237, v237, v34, v60
    v_rcp_f32 v239, v239
    v_mul_f32 v93, v93, v237
    v_mfma_f32_32x32x16_bf16 v[112:127], v[144:147], v[176:179], v[112:127]
    v_fma_f32 v238, v238, v34, v60
    v_cvt_pk_bf16_f32 v254, v92, v93
    v_mul_f32 v94, v94, v238
    v_mfma_f32_32x32x16_bf16 v[112:127], v[148:151], v[180:183], v[112:127]
    v_fma_f32 v239, v239, v34, v60
    v_mul_f32 v95, v95, v239
    v_cvt_pk_bf16_f32 v255, v94, v95
    s_mul_i32 s67, s58, 112
    v_mfma_f32_32x32x16_bf16 v[112:127], v[152:155], v[184:187], v[112:127]
    s_add_u32 s68, s57, 1
    s_lshl_b32 s68, s68, 1
    s_add_u32 s67, s67, s68
    v_mfma_f32_32x32x16_bf16 v[112:127], v[156:159], v[188:191], v[112:127]
    s_lshl_b32 s67, s67, 10
    s_add_u32 s67, s67, 8388608
    buffer_store_dwordx4 v[248:251], v2, s[36:39], s67 offen sc1
    buffer_store_dwordx4 v[252:255], v2, s[36:39], s67 offen offset:1024 sc1
    s_nop 7
    s_lshl_b32 s60, s53, 7
    v_lshlrev_b32 v5, 2, v1
    v_add_u32 v5, s60, v5
    v_add_u32 v5, 135168, v5
    s_mov_b64 exec, 0xffff
    v_add_u32 v6, 0, v5
    ds_write2_b32 v6, v216, v217 offset0:0 offset1:16
    v_add_u32 v6, 512, v5
    ds_write2_b32 v6, v220, v221 offset0:0 offset1:16
    s_mov_b64 exec, -1
    s_waitcnt lgkmcnt(0)
    s_barrier
    v_and_b32 v5, 31, v1
    v_lshlrev_b32 v5, 2, v5
    v_add_u32 v6, 135168, v5
    ds_read2_b32 v[232:233], v6 offset0:0 offset1:32
    ds_read2_b32 v[234:235], v6 offset0:64 offset1:96
    s_waitcnt lgkmcnt(0)
    v_add_f32 v232, v232, v233
    v_add_f32 v234, v234, v235
    v_add_f32 v232, v232, v234
    v_cvt_pk_bf16_f32 v233, v232, v232
    v_and_b32 v233, 0xffff0000, v233
    v_sub_f32 v233, v232, v233
    v_cvt_pk_bf16_f32 v16, v232, v233
    v_mov_b32 v17, v16
    v_mov_b32 v18, 0
    v_mov_b32 v19, 0
    s_nop 1
    v_mfma_f32_32x32x16_bf16 v[96:111], v[16:19], v[12:15], v[96:111]
    v_and_b32 v5, 31, v1
    v_lshlrev_b32 v5, 2, v5
    v_add_u32 v6, 135680, v5
    ds_read2_b32 v[232:233], v6 offset0:0 offset1:32
    ds_read2_b32 v[234:235], v6 offset0:64 offset1:96
    s_waitcnt lgkmcnt(0)
    v_add_f32 v232, v232, v233
    v_add_f32 v234, v234, v235
    v_add_f32 v232, v232, v234
    v_cvt_pk_bf16_f32 v233, v232, v232
    v_and_b32 v233, 0xffff0000, v233
    v_sub_f32 v233, v232, v233
    v_cvt_pk_bf16_f32 v16, v232, v233
    v_mov_b32 v17, v16
    v_mov_b32 v18, 0
    v_mov_b32 v19, 0
    s_nop 1
    v_mfma_f32_32x32x16_bf16 v[112:127], v[16:19], v[12:15], v[112:127]
    s_nop 15
    v_pk_mul_f32 v[96:97], v[96:97], v[38:39] op_sel_hi:[1,0]
    v_pk_mul_f32 v[98:99], v[98:99], v[38:39] op_sel_hi:[1,0]
    v_pk_mul_f32 v[100:101], v[100:101], v[38:39] op_sel_hi:[1,0]
    v_pk_mul_f32 v[102:103], v[102:103], v[38:39] op_sel_hi:[1,0]
    v_pk_mul_f32 v[104:105], v[104:105], v[38:39] op_sel_hi:[1,0]
    v_pk_mul_f32 v[106:107], v[106:107], v[38:39] op_sel_hi:[1,0]
    v_pk_mul_f32 v[108:109], v[108:109], v[38:39] op_sel_hi:[1,0]
    v_pk_mul_f32 v[110:111], v[110:111], v[38:39] op_sel_hi:[1,0]
    v_cvt_pk_bf16_f32 v128, v96, v97
    v_cvt_pk_bf16_f32 v129, v98, v99
    v_cvt_pk_bf16_f32 v130, v100, v101
    v_cvt_pk_bf16_f32 v131, v102, v103
    v_cvt_pk_bf16_f32 v132, v104, v105
    v_cvt_pk_bf16_f32 v133, v106, v107
    v_cvt_pk_bf16_f32 v134, v108, v109
    v_cvt_pk_bf16_f32 v135, v110, v111
    s_lshl_b32 s67, s56, 17
    s_lshl_b32 s61, s58, 10
    s_add_u32 s67, s67, s61
    s_add_u32 s67, s67, 0
    s_add_u32 s68, s67, 65536
    buffer_store_dwordx4 v[128:131], v2, s[36:39], s67 offen sc1
    buffer_store_dwordx4 v[132:135], v2, s[36:39], s68 offen sc1
    v_pk_mul_f32 v[112:113], v[112:113], v[36:37] op_sel_hi:[1,0]
    v_pk_mul_f32 v[114:115], v[114:115], v[36:37] op_sel_hi:[1,0]
    v_pk_mul_f32 v[116:117], v[116:117], v[36:37] op_sel_hi:[1,0]
    v_pk_mul_f32 v[118:119], v[118:119], v[36:37] op_sel_hi:[1,0]
    v_pk_mul_f32 v[120:121], v[120:121], v[36:37] op_sel_hi:[1,0]
    v_pk_mul_f32 v[122:123], v[122:123], v[36:37] op_sel_hi:[1,0]
    v_pk_mul_f32 v[124:125], v[124:125], v[36:37] op_sel_hi:[1,0]
    v_pk_mul_f32 v[126:127], v[126:127], v[36:37] op_sel_hi:[1,0]
    v_cvt_pk_bf16_f32 v136, v112, v113
    v_cvt_pk_bf16_f32 v137, v114, v115
    v_cvt_pk_bf16_f32 v138, v116, v117
    v_cvt_pk_bf16_f32 v139, v118, v119
    v_cvt_pk_bf16_f32 v140, v120, v121
    v_cvt_pk_bf16_f32 v141, v122, v123
    v_cvt_pk_bf16_f32 v142, v124, v125
    v_cvt_pk_bf16_f32 v143, v126, v127
    s_lshl_b32 s67, s56, 17
    s_lshl_b32 s61, s58, 10
    s_add_u32 s67, s67, s61
    s_add_u32 s67, s67, 2097152
    s_add_u32 s68, s67, 65536
    buffer_store_dwordx4 v[136:139], v2, s[36:39], s67 offen sc1
    buffer_store_dwordx4 v[140:143], v2, s[36:39], s68 offen sc1
    s_branch gemm1_kernel_done
gemm1_kernel_g1:
    s_waitcnt vmcnt(7)
    s_barrier
    ds_read_b128 v[160:163], v40 offset:0
    ds_read_b128 v[164:167], v41 offset:0
    ds_read_b128 v[168:171], v42 offset:0
    ds_read_b128 v[172:175], v43 offset:0
    ds_read_b64_tr_b16 v[128:129], v56 offset:0
    ds_read_b64_tr_b16 v[130:131], v56 offset:256
    ds_read_b64_tr_b16 v[132:133], v57 offset:0
    ds_read_b64_tr_b16 v[134:135], v57 offset:256
    ds_read_b64_tr_b16 v[136:137], v58 offset:0
    ds_read_b64_tr_b16 v[138:139], v58 offset:256
    ds_read_b64_tr_b16 v[140:141], v59 offset:0
    ds_read_b64_tr_b16 v[142:143], v59 offset:256
    ds_read_b64_tr_b16 v[144:145], v56 offset:4096
    ds_read_b64_tr_b16 v[146:147], v56 offset:4352
    ds_read_b64_tr_b16 v[148:149], v57 offset:4096
    ds_read_b64_tr_b16 v[150:151], v57 offset:4352
    ds_read_b64_tr_b16 v[152:153], v58 offset:4096
    ds_read_b64_tr_b16 v[154:155], v58 offset:4352
    ds_read_b64_tr_b16 v[156:157], v59 offset:4096
    ds_read_b64_tr_b16 v[158:159], v59 offset:4352
    s_lshl_b32 s60, s78, 7
    s_add_u32 s60, s60, s69
    s_mul_i32 s61, s78, 229376
    s_add_u32 s78, s78, 1
    s_and_b32 s78, s78, 7
    s_add_u32 m0, s70, 65536
    s_add_u32 s63, s60, 7168
    buffer_load_dwordx4 v48, s[24:27], s60 offen lds
    buffer_load_dwordx4 v49, s[24:27], s63 offen offset:1024 lds
    s_add_u32 m0, s75, 65536
    s_add_u32 s63, s61, s71
    buffer_load_dwordx4 v51, s[32:35], s63 offen lds
    s_cmp_eq_u32 s64, 0
    s_cbranch_scc1 gemm1_kernel_od2
    s_add_u32 m0, s75, 69632
    s_add_u32 s63, s61, s72
    buffer_load_dwordx4 v51, s[32:35], s63 offen lds
gemm1_kernel_od2:
    s_waitcnt vmcnt(7)
    s_barrier
    s_waitcnt lgkmcnt(0)
    v_mfma_f32_16x16x32_bf16 v[208:211], v[8:11], v[128:131], v[208:211]
    v_mfma_f32_32x32x16_bf16 v[64:79], v[128:131], v[160:163], v[64:79]
    ds_read_b64_tr_b16 v[128:129], v56 offset:32768
    ds_read_b64_tr_b16 v[130:131], v56 offset:33024
    ds_read_b128 v[176:179], v40 offset:32768
    v_mfma_f32_32x32x16_bf16 v[64:79], v[132:135], v[164:167], v[64:79]
    ds_read_b64_tr_b16 v[132:133], v57 offset:32768
    ds_read_b64_tr_b16 v[134:135], v57 offset:33024
    ds_read_b128 v[180:183], v41 offset:32768
    s_lshl_b32 s60, s78, 7
    s_add_u32 s60, s60, s69
    s_mul_i32 s61, s78, 229376
    s_add_u32 s78, s78, 1
    s_and_b32 s78, s78, 7
    s_add_u32 m0, s70, 98304
    s_add_u32 s63, s60, 7168
    buffer_load_dwordx4 v48, s[24:27], s60 offen lds
    buffer_load_dwordx4 v49, s[24:27], s63 offen offset:1024 lds
    v_mfma_f32_32x32x16_bf16 v[64:79], v[136:139], v[168:171], v[64:79]
    ds_read_b64_tr_b16 v[136:137], v58 offset:32768
    ds_read_b64_tr_b16 v[138:139], v58 offset:33024
    ds_read_b128 v[184:187], v42 offset:32768
    v_mfma_f32_32x32x16_bf16 v[64:79], v[140:143], v[172:175], v[64:79]
    ds_read_b64_tr_b16 v[140:141], v59 offset:32768
    ds_read_b64_tr_b16 v[142:143], v59 offset:33024
    ds_read_b128 v[188:191], v43 offset:32768
    s_add_u32 m0, s75, 98304
    s_add_u32 s63, s61, s71
    buffer_load_dwordx4 v51, s[32:35], s63 offen lds
    s_cmp_eq_u32 s64, 0
    s_cbranch_scc1 gemm1_kernel_g1_t1
    s_waitcnt lgkmcnt(12)
    v_mfma_f32_16x16x32_bf16 v[212:215], v[8:11], v[144:147], v[212:215]
    v_mfma_f32_32x32x16_bf16 v[80:95], v[144:147], v[160:163], v[80:95]
    ds_read_b64_tr_b16 v[144:145], v56 offset:36864
    ds_read_b64_tr_b16 v[146:147], v56 offset:37120
    v_mfma_f32_32x32x16_bf16 v[80:95], v[148:151], v[164:167], v[80:95]
    ds_read_b64_tr_b16 v[148:149], v57 offset:36864
    ds_read_b64_tr_b16 v[150:151], v57 offset:37120
    v_mfma_f32_32x32x16_bf16 v[80:95], v[152:155], v[168:171], v[80:95]
    ds_read_b64_tr_b16 v[152:153], v58 offset:36864
    ds_read_b64_tr_b16 v[154:155], v58 offset:37120
    v_mfma_f32_32x32x16_bf16 v[80:95], v[156:159], v[172:175], v[80:95]
    ds_read_b64_tr_b16 v[156:157], v59 offset:36864
    ds_read_b64_tr_b16 v[158:159], v59 offset:37120
    s_add_u32 m0, s75, 102400
    s_add_u32 s63, s61, s72
    buffer_load_dwordx4 v51, s[32:35], s63 offen lds
gemm1_kernel_g1_t1:
    v_mfma_f32_16x16x32_bf16 v[20:23], v[8:11], v[160:163], v[20:23]
    v_mfma_f32_16x16x32_bf16 v[20:23], v[8:11], v[164:167], v[20:23]
    v_mfma_f32_16x16x32_bf16 v[20:23], v[8:11], v[168:171], v[20:23]
    v_mfma_f32_16x16x32_bf16 v[20:23], v[8:11], v[172:175], v[20:23]
    s_waitcnt vmcnt(3)
    s_barrier
    s_waitcnt lgkmcnt(0)
    v_mfma_f32_16x16x32_bf16 v[208:211], v[8:11], v[128:131], v[208:211]
    v_mfma_f32_32x32x16_bf16 v[64:79], v[128:131], v[176:179], v[64:79]
    ds_read_b64_tr_b16 v[128:129], v28 offset:0
    ds_read_b64_tr_b16 v[130:131], v28 offset:256
    ds_read_b128 v[160:163], v44 offset:0
    v_mfma_f32_32x32x16_bf16 v[64:79], v[132:135], v[180:183], v[64:79]
    ds_read_b64_tr_b16 v[132:133], v29 offset:0
    ds_read_b64_tr_b16 v[134:135], v29 offset:256
    ds_read_b128 v[164:167], v45 offset:0
    s_lshl_b32 s60, s78, 7
    s_add_u32 s60, s60, s69
    s_mul_i32 s61, s78, 229376
    s_add_u32 s78, s78, 1
    s_and_b32 s78, s78, 7
    s_add_u32 m0, s70, 0
    s_add_u32 s63, s60, 7168
    buffer_load_dwordx4 v48, s[24:27], s60 offen lds
    buffer_load_dwordx4 v49, s[24:27], s63 offen offset:1024 lds
    v_mfma_f32_32x32x16_bf16 v[64:79], v[136:139], v[184:187], v[64:79]
    ds_read_b64_tr_b16 v[136:137], v30 offset:0
    ds_read_b64_tr_b16 v[138:139], v30 offset:256
    ds_read_b128 v[168:171], v46 offset:0
    v_mfma_f32_32x32x16_bf16 v[64:79], v[140:143], v[188:191], v[64:79]
    ds_read_b64_tr_b16 v[140:141], v31 offset:0
    ds_read_b64_tr_b16 v[142:143], v31 offset:256
    ds_read_b128 v[172:175], v47 offset:0
    s_add_u32 m0, s75, 0
    s_add_u32 s63, s61, s71
    buffer_load_dwordx4 v51, s[32:35], s63 offen lds
    s_cmp_eq_u32 s64, 0
    s_cbranch_scc1 gemm1_kernel_g1_t2
    s_waitcnt lgkmcnt(12)
    v_mfma_f32_16x16x32_bf16 v[212:215], v[8:11], v[144:147], v[212:215]
    v_mfma_f32_32x32x16_bf16 v[80:95], v[144:147], v[176:179], v[80:95]
    ds_read_b64_tr_b16 v[144:145], v28 offset:4096
    ds_read_b64_tr_b16 v[146:147], v28 offset:4352
    v_mfma_f32_32x32x16_bf16 v[80:95], v[148:151], v[180:183], v[80:95]
    ds_read_b64_tr_b16 v[148:149], v29 offset:4096
    ds_read_b64_tr_b16 v[150:151], v29 offset:4352
    v_mfma_f32_32x32x16_bf16 v[80:95], v[152:155], v[184:187], v[80:95]
    ds_read_b64_tr_b16 v[152:153], v30 offset:4096
    ds_read_b64_tr_b16 v[154:155], v30 offset:4352
    v_mfma_f32_32x32x16_bf16 v[80:95], v[156:159], v[188:191], v[80:95]
    ds_read_b64_tr_b16 v[156:157], v31 offset:4096
    ds_read_b64_tr_b16 v[158:159], v31 offset:4352
    s_add_u32 m0, s75, 4096
    s_add_u32 s63, s61, s72
    buffer_load_dwordx4 v51, s[32:35], s63 offen lds
gemm1_kernel_g1_t2:
    v_mfma_f32_16x16x32_bf16 v[20:23], v[8:11], v[176:179], v[20:23]
    v_mfma_f32_16x16x32_bf16 v[20:23], v[8:11], v[180:183], v[20:23]
    v_mfma_f32_16x16x32_bf16 v[20:23], v[8:11], v[184:187], v[20:23]
    v_mfma_f32_16x16x32_bf16 v[20:23], v[8:11], v[188:191], v[20:23]
    s_waitcnt vmcnt(3)
    s_barrier
    s_waitcnt lgkmcnt(0)
    v_mfma_f32_16x16x32_bf16 v[208:211], v[8:11], v[128:131], v[208:211]
    v_mfma_f32_32x32x16_bf16 v[64:79], v[128:131], v[160:163], v[64:79]
    ds_read_b64_tr_b16 v[128:129], v28 offset:32768
    ds_read_b64_tr_b16 v[130:131], v28 offset:33024
    ds_read_b128 v[176:179], v44 offset:32768
    v_mfma_f32_32x32x16_bf16 v[64:79], v[132:135], v[164:167], v[64:79]
    ds_read_b64_tr_b16 v[132:133], v29 offset:32768
    ds_read_b64_tr_b16 v[134:135], v29 offset:33024
    ds_read_b128 v[180:183], v45 offset:32768
    s_lshl_b32 s60, s78, 7
    s_add_u32 s60, s60, s69
    s_mul_i32 s61, s78, 229376
    s_add_u32 s78, s78, 1
    s_and_b32 s78, s78, 7
    s_add_u32 m0, s70, 32768
    s_add_u32 s63, s60, 7168
    buffer_load_dwordx4 v48, s[24:27], s60 offen lds
    buffer_load_dwordx4 v49, s[24:27], s63 offen offset:1024 lds
    v_mfma_f32_32x32x16_bf16 v[64:79], v[136:139], v[168:171], v[64:79]
    ds_read_b64_tr_b16 v[136:137], v30 offset:32768
    ds_read_b64_tr_b16 v[138:139], v30 offset:33024
    ds_read_b128 v[184:187], v46 offset:32768
    v_mfma_f32_32x32x16_bf16 v[64:79], v[140:143], v[172:175], v[64:79]
    ds_read_b64_tr_b16 v[140:141], v31 offset:32768
    ds_read_b64_tr_b16 v[142:143], v31 offset:33024
    ds_read_b128 v[188:191], v47 offset:32768
    s_add_u32 m0, s75, 32768
    s_add_u32 s63, s61, s71
    buffer_load_dwordx4 v51, s[32:35], s63 offen lds
    s_cmp_eq_u32 s64, 0
    s_cbranch_scc1 gemm1_kernel_g1_t3
    s_waitcnt lgkmcnt(12)
    v_mfma_f32_16x16x32_bf16 v[212:215], v[8:11], v[144:147], v[212:215]
    v_mfma_f32_32x32x16_bf16 v[80:95], v[144:147], v[160:163], v[80:95]
    ds_read_b64_tr_b16 v[144:145], v28 offset:36864
    ds_read_b64_tr_b16 v[146:147], v28 offset:37120
    v_mfma_f32_32x32x16_bf16 v[80:95], v[148:151], v[164:167], v[80:95]
    ds_read_b64_tr_b16 v[148:149], v29 offset:36864
    ds_read_b64_tr_b16 v[150:151], v29 offset:37120
    v_mfma_f32_32x32x16_bf16 v[80:95], v[152:155], v[168:171], v[80:95]
    ds_read_b64_tr_b16 v[152:153], v30 offset:36864
    ds_read_b64_tr_b16 v[154:155], v30 offset:37120
    v_mfma_f32_32x32x16_bf16 v[80:95], v[156:159], v[172:175], v[80:95]
    ds_read_b64_tr_b16 v[156:157], v31 offset:36864
    ds_read_b64_tr_b16 v[158:159], v31 offset:37120
    s_add_u32 m0, s75, 36864
    s_add_u32 s63, s61, s72
    buffer_load_dwordx4 v51, s[32:35], s63 offen lds
gemm1_kernel_g1_t3:
    v_mfma_f32_16x16x32_bf16 v[20:23], v[8:11], v[160:163], v[20:23]
    v_mfma_f32_16x16x32_bf16 v[20:23], v[8:11], v[164:167], v[20:23]
    v_mfma_f32_16x16x32_bf16 v[20:23], v[8:11], v[168:171], v[20:23]
    v_mfma_f32_16x16x32_bf16 v[20:23], v[8:11], v[172:175], v[20:23]
    s_and_b32 s60, s2, 15
    s_lshr_b32 s63, s2, 4
    s_mul_i32 s61, s60, 7
    s_add_u32 s61, s61, s52
    s_lshl_b32 s62, s60, 1
    s_cmp_eq_u32 s52, 7
    s_cselect_b32 s88, s48, s44
    s_cselect_b32 s89, s49, s45
    s_cselect_b32 s90, s50, s46
    s_mov_b32 s91, 0x20000
    s_cselect_b32 s61, s62, s61
    s_cselect_b32 s93, 32, 0x70
    s_cselect_b32 s94, 2097152, 0
    s_mul_i32 s93, s93, s63
    s_add_u32 s93, s93, s61
    s_lshl_b32 s93, s93, 10
    s_add_u32 s93, s93, s94
    s_add_u32 s93, s93, 16777216
    s_lshl_b32 s61, s61, 14
    s_lshl_b32 s63, s63, 6
    s_add_u32 s61, s61, s63
    s_lshl_b32 s95, s52, 10
    s_add_u32 m0, s95, 139264
    s_lshl_b32 s62, s62, 14
    buffer_load_dwordx4 v52, s[88:91], s61 offen lds
    s_add_u32 s62, s62, s63
    s_add_u32 s62, s62, 16384
    s_mov_b32 m0, 147456
    s_lshr_b32 s63, s2, 4
    s_lshl_b32 s94, s63, 5
    buffer_load_dwordx4 v52, s[48:51], s62 offen lds
    s_lshl_b32 s60, s60, 1
    s_add_u32 s94, s94, s60
    s_add_u32 s94, s94, 1
    s_lshl_b32 s94, s94, 10
    s_add_u32 s94, s94, 18874368
    s_waitcnt vmcnt(5)
    s_barrier
    s_waitcnt lgkmcnt(0)
    v_mfma_f32_16x16x32_bf16 v[208:211], v[8:11], v[128:131], v[208:211]
    v_mfma_f32_32x32x16_bf16 v[64:79], v[128:131], v[176:179], v[64:79]
    ds_read_b64_tr_b16 v[128:129], v56 offset:0
    ds_read_b64_tr_b16 v[130:131], v56 offset:256
    ds_read_b128 v[160:163], v40 offset:0
    v_mfma_f32_32x32x16_bf16 v[64:79], v[132:135], v[180:183], v[64:79]
    ds_read_b64_tr_b16 v[132:133], v57 offset:0
    ds_read_b64_tr_b16 v[134:135], v57 offset:256
    ds_read_b128 v[164:167], v41 offset:0
    s_lshl_b32 s60, s78, 7
    s_add_u32 s60, s60, s69
    s_mul_i32 s61, s78, 229376
    s_add_u32 s78, s78, 1
    s_and_b32 s78, s78, 7
    s_add_u32 m0, s70, 65536
    s_add_u32 s63, s60, 7168
    buffer_load_dwordx4 v48, s[24:27], s60 offen lds
    buffer_load_dwordx4 v49, s[24:27], s63 offen offset:1024 lds
    v_mfma_f32_32x32x16_bf16 v[64:79], v[136:139], v[184:187], v[64:79]
    ds_read_b64_tr_b16 v[136:137], v58 offset:0
    ds_read_b64_tr_b16 v[138:139], v58 offset:256
    ds_read_b128 v[168:171], v42 offset:0
    v_mfma_f32_32x32x16_bf16 v[64:79], v[140:143], v[188:191], v[64:79]
    ds_read_b64_tr_b16 v[140:141], v59 offset:0
    ds_read_b64_tr_b16 v[142:143], v59 offset:256
    ds_read_b128 v[172:175], v43 offset:0
    s_add_u32 m0, s75, 65536
    s_add_u32 s63, s61, s71
    buffer_load_dwordx4 v51, s[32:35], s63 offen lds
    s_cmp_eq_u32 s64, 0
    s_cbranch_scc1 gemm1_kernel_g1_t4
    s_waitcnt lgkmcnt(12)
    v_mfma_f32_16x16x32_bf16 v[212:215], v[8:11], v[144:147], v[212:215]
    v_mfma_f32_32x32x16_bf16 v[80:95], v[144:147], v[176:179], v[80:95]
    ds_read_b64_tr_b16 v[144:145], v56 offset:4096
    ds_read_b64_tr_b16 v[146:147], v56 offset:4352
    v_mfma_f32_32x32x16_bf16 v[80:95], v[148:151], v[180:183], v[80:95]
    ds_read_b64_tr_b16 v[148:149], v57 offset:4096
    ds_read_b64_tr_b16 v[150:151], v57 offset:4352
    v_mfma_f32_32x32x16_bf16 v[80:95], v[152:155], v[184:187], v[80:95]
    ds_read_b64_tr_b16 v[152:153], v58 offset:4096
    ds_read_b64_tr_b16 v[154:155], v58 offset:4352
    v_mfma_f32_32x32x16_bf16 v[80:95], v[156:159], v[188:191], v[80:95]
    ds_read_b64_tr_b16 v[156:157], v59 offset:4096
    ds_read_b64_tr_b16 v[158:159], v59 offset:4352
    s_add_u32 m0, s75, 69632
    s_add_u32 s63, s61, s72
    buffer_load_dwordx4 v51, s[32:35], s63 offen lds
gemm1_kernel_g1_t4:
    v_mfma_f32_16x16x32_bf16 v[20:23], v[8:11], v[176:179], v[20:23]
    v_mfma_f32_16x16x32_bf16 v[20:23], v[8:11], v[180:183], v[20:23]
    v_mfma_f32_16x16x32_bf16 v[20:23], v[8:11], v[184:187], v[20:23]
    v_mfma_f32_16x16x32_bf16 v[20:23], v[8:11], v[188:191], v[20:23]
    s_waitcnt vmcnt(5)
    s_barrier
    s_waitcnt lgkmcnt(0)
    v_mfma_f32_16x16x32_bf16 v[208:211], v[8:11], v[128:131], v[208:211]
    v_mfma_f32_32x32x16_bf16 v[64:79], v[128:131], v[160:163], v[64:79]
    ds_read_b64_tr_b16 v[128:129], v56 offset:32768
    ds_read_b64_tr_b16 v[130:131], v56 offset:33024
    ds_read_b128 v[176:179], v40 offset:32768
    v_mfma_f32_32x32x16_bf16 v[64:79], v[132:135], v[164:167], v[64:79]
    ds_read_b64_tr_b16 v[132:133], v57 offset:32768
    ds_read_b64_tr_b16 v[134:135], v57 offset:33024
    ds_read_b128 v[180:183], v41 offset:32768
    s_lshl_b32 s60, s78, 7
    s_add_u32 s60, s60, s69
    s_mul_i32 s61, s78, 229376
    s_add_u32 s78, s78, 1
    s_and_b32 s78, s78, 7
    s_add_u32 m0, s70, 98304
    s_add_u32 s63, s60, 7168
    buffer_load_dwordx4 v48, s[24:27], s60 offen lds
    buffer_load_dwordx4 v49, s[24:27], s63 offen offset:1024 lds
    v_mfma_f32_32x32x16_bf16 v[64:79], v[136:139], v[168:171], v[64:79]
    ds_read_b64_tr_b16 v[136:137], v58 offset:32768
    ds_read_b64_tr_b16 v[138:139], v58 offset:33024
    ds_read_b128 v[184:187], v42 offset:32768
    v_mfma_f32_32x32x16_bf16 v[64:79], v[140:143], v[172:175], v[64:79]
    ds_read_b64_tr_b16 v[140:141], v59 offset:32768
    ds_read_b64_tr_b16 v[142:143], v59 offset:33024
    ds_read_b128 v[188:191], v43 offset:32768
    s_add_u32 m0, s75, 98304
    s_add_u32 s63, s61, s71
    buffer_load_dwordx4 v51, s[32:35], s63 offen lds
    s_cmp_eq_u32 s64, 0
    s_cbranch_scc1 gemm1_kernel_g1_t5
    s_waitcnt lgkmcnt(12)
    v_mfma_f32_16x16x32_bf16 v[212:215], v[8:11], v[144:147], v[212:215]
    v_mfma_f32_32x32x16_bf16 v[80:95], v[144:147], v[160:163], v[80:95]
    ds_read_b64_tr_b16 v[144:145], v56 offset:36864
    ds_read_b64_tr_b16 v[146:147], v56 offset:37120
    v_mfma_f32_32x32x16_bf16 v[80:95], v[148:151], v[164:167], v[80:95]
    ds_read_b64_tr_b16 v[148:149], v57 offset:36864
    ds_read_b64_tr_b16 v[150:151], v57 offset:37120
    v_mfma_f32_32x32x16_bf16 v[80:95], v[152:155], v[168:171], v[80:95]
    ds_read_b64_tr_b16 v[152:153], v58 offset:36864
    ds_read_b64_tr_b16 v[154:155], v58 offset:37120
    v_mfma_f32_32x32x16_bf16 v[80:95], v[156:159], v[172:175], v[80:95]
    ds_read_b64_tr_b16 v[156:157], v59 offset:36864
    ds_read_b64_tr_b16 v[158:159], v59 offset:37120
    s_add_u32 m0, s75, 102400
    s_add_u32 s63, s61, s72
    buffer_load_dwordx4 v51, s[32:35], s63 offen lds
gemm1_kernel_g1_t5:
    v_mfma_f32_16x16x32_bf16 v[20:23], v[8:11], v[160:163], v[20:23]
    v_mfma_f32_16x16x32_bf16 v[20:23], v[8:11], v[164:167], v[20:23]
    v_mfma_f32_16x16x32_bf16 v[20:23], v[8:11], v[168:171], v[20:23]
    v_mfma_f32_16x16x32_bf16 v[20:23], v[8:11], v[172:175], v[20:23]
    s_waitcnt vmcnt(3)
    s_barrier
    s_waitcnt lgkmcnt(0)
    v_mfma_f32_16x16x32_bf16 v[208:211], v[8:11], v[128:131], v[208:211]
    v_mfma_f32_32x32x16_bf16 v[64:79], v[128:131], v[176:179], v[64:79]
    ds_read_b64_tr_b16 v[128:129], v28 offset:0
    ds_read_b64_tr_b16 v[130:131], v28 offset:256
    ds_read_b128 v[160:163], v44 offset:0
    v_mfma_f32_32x32x16_bf16 v[64:79], v[132:135], v[180:183], v[64:79]
    ds_read_b64_tr_b16 v[132:133], v29 offset:0
    ds_read_b64_tr_b16 v[134:135], v29 offset:256
    ds_read_b128 v[164:167], v45 offset:0
    s_lshl_b32 s60, s78, 7
    s_add_u32 s60, s60, s69
    s_mul_i32 s61, s78, 196608
    s_add_u32 s78, s78, 1
    s_and_b32 s78, s78, 7
    s_add_u32 m0, s70, 0
    s_add_u32 s63, s60, 7168
    buffer_load_dwordx4 v48, s[24:27], s60 offen lds
    buffer_load_dwordx4 v49, s[24:27], s63 offen offset:1024 lds
    v_mfma_f32_32x32x16_bf16 v[64:79], v[136:139], v[184:187], v[64:79]
    ds_read_b64_tr_b16 v[136:137], v30 offset:0
    ds_read_b64_tr_b16 v[138:139], v30 offset:256
    ds_read_b128 v[168:171], v46 offset:0
    v_mfma_f32_32x32x16_bf16 v[64:79], v[140:143], v[188:191], v[64:79]
    ds_read_b64_tr_b16 v[140:141], v31 offset:0
    ds_read_b64_tr_b16 v[142:143], v31 offset:256
    ds_read_b128 v[172:175], v47 offset:0
    s_add_u32 m0, s75, 0
    s_add_u32 s63, s61, s73
    buffer_load_dwordx4 v50, s[28:31], s63 offen lds
    s_cmp_eq_u32 s64, 0
    s_cbranch_scc1 gemm1_kernel_g1_t6
    s_waitcnt lgkmcnt(12)
    v_mfma_f32_16x16x32_bf16 v[212:215], v[8:11], v[144:147], v[212:215]
    v_mfma_f32_32x32x16_bf16 v[80:95], v[144:147], v[176:179], v[80:95]
    ds_read_b64_tr_b16 v[144:145], v28 offset:4096
    ds_read_b64_tr_b16 v[146:147], v28 offset:4352
    v_mfma_f32_32x32x16_bf16 v[80:95], v[148:151], v[180:183], v[80:95]
    ds_read_b64_tr_b16 v[148:149], v29 offset:4096
    ds_read_b64_tr_b16 v[150:151], v29 offset:4352
    v_mfma_f32_32x32x16_bf16 v[80:95], v[152:155], v[184:187], v[80:95]
    ds_read_b64_tr_b16 v[152:153], v30 offset:4096
    ds_read_b64_tr_b16 v[154:155], v30 offset:4352
    v_mfma_f32_32x32x16_bf16 v[80:95], v[156:159], v[188:191], v[80:95]
    ds_read_b64_tr_b16 v[156:157], v31 offset:4096
    ds_read_b64_tr_b16 v[158:159], v31 offset:4352
gemm1_kernel_g1_t6:
    v_mfma_f32_16x16x32_bf16 v[20:23], v[8:11], v[176:179], v[20:23]
    v_mfma_f32_16x16x32_bf16 v[20:23], v[8:11], v[180:183], v[20:23]
    v_mfma_f32_16x16x32_bf16 v[20:23], v[8:11], v[184:187], v[20:23]
    v_mfma_f32_16x16x32_bf16 v[20:23], v[8:11], v[188:191], v[20:23]
    s_waitcnt vmcnt(9)
    v_add_u32 v5, s95, v54
    v_add_u32 v5, 139264, v5
    ds_read_b64_tr_b16 v[224:225], v5
    ds_read_b64_tr_b16 v[226:227], v5 offset:512
    v_add_u32 v5, 147456, v54
    ds_read_b64_tr_b16 v[228:229], v5
    ds_read_b64_tr_b16 v[230:231], v5 offset:512
    s_waitcnt lgkmcnt(0)
    buffer_store_dwordx4 v[224:227], v2, s[36:39], s93 offen sc1
    s_cmp_eq_u32 s52, 0
    s_cbranch_scc0 gemm1_kernel_g1_pp
    buffer_store_dwordx4 v[228:231], v2, s[36:39], s94 offen sc1
gemm1_kernel_g1_pp:
    s_waitcnt vmcnt(4)
    s_barrier
    s_waitcnt lgkmcnt(0)
    v_mfma_f32_16x16x32_bf16 v[208:211], v[8:11], v[128:131], v[208:211]
    v_mfma_f32_32x32x16_bf16 v[64:79], v[128:131], v[160:163], v[64:79]
    ds_read_b64_tr_b16 v[128:129], v28 offset:32768
    ds_read_b64_tr_b16 v[130:131], v28 offset:33024
    ds_read_b128 v[176:179], v44 offset:32768
    v_mfma_f32_32x32x16_bf16 v[64:79], v[132:135], v[164:167], v[64:79]
    ds_read_b64_tr_b16 v[132:133], v29 offset:32768
    ds_read_b64_tr_b16 v[134:135], v29 offset:33024
    ds_read_b128 v[180:183], v45 offset:32768
    s_lshl_b32 s60, s78, 7
    s_add_u32 s60, s60, s69
    s_mul_i32 s61, s78, 196608
    s_add_u32 s78, s78, 1
    s_and_b32 s78, s78, 7
    s_add_u32 m0, s70, 32768
    s_add_u32 s63, s60, 7168
    buffer_load_dwordx4 v48, s[24:27], s60 offen lds
    buffer_load_dwordx4 v49, s[24:27], s63 offen offset:1024 lds
    v_mfma_f32_32x32x16_bf16 v[64:79], v[136:139], v[168:171], v[64:79]
    ds_read_b64_tr_b16 v[136:137], v30 offset:32768
    ds_read_b64_tr_b16 v[138:139], v30 offset:33024
    ds_read_b128 v[184:187], v46 offset:32768
    v_mfma_f32_32x32x16_bf16 v[64:79], v[140:143], v[172:175], v[64:79]
    ds_read_b64_tr_b16 v[140:141], v31 offset:32768
    ds_read_b64_tr_b16 v[142:143], v31 offset:33024
    ds_read_b128 v[188:191], v47 offset:32768
    s_add_u32 m0, s75, 32768
    s_add_u32 s63, s61, s73
    buffer_load_dwordx4 v50, s[28:31], s63 offen lds
    s_cmp_eq_u32 s64, 0
    s_cbranch_scc1 gemm1_kernel_g1_t7
    s_waitcnt lgkmcnt(12)
    v_mfma_f32_16x16x32_bf16 v[212:215], v[8:11], v[144:147], v[212:215]
    v_mfma_f32_32x32x16_bf16 v[80:95], v[144:147], v[160:163], v[80:95]
    ds_read_b64_tr_b16 v[144:145], v28 offset:36864
    ds_read_b64_tr_b16 v[146:147], v28 offset:37120
    v_mfma_f32_32x32x16_bf16 v[80:95], v[148:151], v[164:167], v[80:95]
    ds_read_b64_tr_b16 v[148:149], v29 offset:36864
    ds_read_b64_tr_b16 v[150:151], v29 offset:37120
    v_mfma_f32_32x32x16_bf16 v[80:95], v[152:155], v[168:171], v[80:95]
    ds_read_b64_tr_b16 v[152:153], v30 offset:36864
    ds_read_b64_tr_b16 v[154:155], v30 offset:37120
    v_mfma_f32_32x32x16_bf16 v[80:95], v[156:159], v[172:175], v[80:95]
    ds_read_b64_tr_b16 v[156:157], v31 offset:36864
    ds_read_b64_tr_b16 v[158:159], v31 offset:37120
gemm1_kernel_g1_t7:
    v_mfma_f32_16x16x32_bf16 v[20:23], v[8:11], v[160:163], v[20:23]
    v_mfma_f32_16x16x32_bf16 v[20:23], v[8:11], v[164:167], v[20:23]
    v_mfma_f32_16x16x32_bf16 v[20:23], v[8:11], v[168:171], v[20:23]
    v_mfma_f32_16x16x32_bf16 v[20:23], v[8:11], v[172:175], v[20:23]
    s_waitcnt vmcnt(4)
    s_barrier
    s_waitcnt lgkmcnt(0)
    v_mfma_f32_16x16x32_bf16 v[208:211], v[8:11], v[128:131], v[208:211]
    v_mfma_f32_32x32x16_bf16 v[64:79], v[128:131], v[176:179], v[64:79]
    ds_read_b64_tr_b16 v[128:129], v56 offset:0
    ds_read_b64_tr_b16 v[130:131], v56 offset:256
    ds_read_b128 v[160:163], v40 offset:0
    v_mfma_f32_32x32x16_bf16 v[64:79], v[132:135], v[180:183], v[64:79]
    ds_read_b64_tr_b16 v[132:133], v57 offset:0
    ds_read_b64_tr_b16 v[134:135], v57 offset:256
    ds_read_b128 v[164:167], v41 offset:0
    s_lshl_b32 s60, s78, 7
    s_add_u32 s60, s60, s69
    s_mul_i32 s61, s78, 196608
    s_add_u32 s78, s78, 1
    s_and_b32 s78, s78, 7
    s_add_u32 m0, s70, 65536
    s_add_u32 s63, s60, 7168
    buffer_load_dwordx4 v48, s[24:27], s60 offen lds
    buffer_load_dwordx4 v49, s[24:27], s63 offen offset:1024 lds
    v_mfma_f32_32x32x16_bf16 v[64:79], v[136:139], v[184:187], v[64:79]
    ds_read_b64_tr_b16 v[136:137], v58 offset:0
    ds_read_b64_tr_b16 v[138:139], v58 offset:256
    ds_read_b128 v[168:171], v42 offset:0
    v_mfma_f32_32x32x16_bf16 v[64:79], v[140:143], v[188:191], v[64:79]
    ds_read_b64_tr_b16 v[140:141], v59 offset:0
    ds_read_b64_tr_b16 v[142:143], v59 offset:256
    ds_read_b128 v[172:175], v43 offset:0
    s_add_u32 m0, s75, 65536
    s_add_u32 s63, s61, s73
    buffer_load_dwordx4 v50, s[28:31], s63 offen lds
    s_cmp_eq_u32 s64, 0
    s_cbranch_scc1 gemm1_kernel_g1_t8
    s_waitcnt lgkmcnt(12)
    v_mfma_f32_16x16x32_bf16 v[212:215], v[8:11], v[144:147], v[212:215]
    v_mfma_f32_32x32x16_bf16 v[80:95], v[144:147], v[176:179], v[80:95]
    v_mfma_f32_32x32x16_bf16 v[80:95], v[148:151], v[180:183], v[80:95]
    v_mfma_f32_32x32x16_bf16 v[80:95], v[152:155], v[184:187], v[80:95]
    v_mfma_f32_32x32x16_bf16 v[80:95], v[156:159], v[188:191], v[80:95]
gemm1_kernel_g1_t8:
    v_mfma_f32_16x16x32_bf16 v[20:23], v[8:11], v[176:179], v[20:23]
    v_mfma_f32_16x16x32_bf16 v[20:23], v[8:11], v[180:183], v[20:23]
    v_mfma_f32_16x16x32_bf16 v[20:23], v[8:11], v[184:187], v[20:23]
    v_mfma_f32_16x16x32_bf16 v[20:23], v[8:11], v[188:191], v[20:23]
    s_nop 7
    s_lshl_b32 s60, s53, 7
    v_lshlrev_b32 v5, 2, v1
    v_add_u32 v5, s60, v5
    v_add_u32 v5, 134144, v5
    s_mov_b64 exec, 0xffff
    v_add_u32 v6, 0, v5
    ds_write2_b32 v6, v208, v209 offset0:0 offset1:16
    v_add_u32 v6, 512, v5
    ds_write2_b32 v6, v212, v213 offset0:0 offset1:16
    v_add_u32 v6, 4294964736, v5
    ds_write2_b32 v6, v20, v21 offset0:0 offset1:16
    s_mov_b64 exec, -1
    s_waitcnt vmcnt(3) lgkmcnt(0)
    s_barrier
    s_waitcnt lgkmcnt(0)
    v_mfma_f32_16x16x32_bf16 v[216:219], v[8:11], v[128:131], v[216:219]
    v_mfma_f32_32x32x16_bf16 v[96:111], v[160:163], v[128:131], v[96:111]
    ds_read_b64_tr_b16 v[128:129], v56 offset:32768
    ds_read_b64_tr_b16 v[130:131], v56 offset:33024
    ds_read_b128 v[176:179], v40 offset:32768
    v_mfma_f32_32x32x16_bf16 v[96:111], v[164:167], v[132:135], v[96:111]
    ds_read_b64_tr_b16 v[132:133], v57 offset:32768
    ds_read_b64_tr_b16 v[134:135], v57 offset:33024
    ds_read_b128 v[180:183], v41 offset:32768
    s_lshl_b32 s60, s78, 7
    s_add_u32 s60, s60, s69
    s_mul_i32 s61, s78, 196608
    s_add_u32 s78, s78, 1
    s_and_b32 s78, s78, 7
    s_add_u32 m0, s70, 98304
    s_add_u32 s63, s60, 7168
    buffer_load_dwordx4 v48, s[24:27], s60 offen lds
    buffer_load_dwordx4 v49, s[24:27], s63 offen offset:1024 lds
    v_mfma_f32_32x32x16_bf16 v[96:111], v[168:171], v[136:139], v[96:111]
    ds_read_b64_tr_b16 v[136:137], v58 offset:32768
    ds_read_b64_tr_b16 v[138:139], v58 offset:33024
    ds_read_b128 v[184:187], v42 offset:32768
    v_mfma_f32_32x32x16_bf16 v[96:111], v[172:175], v[140:143], v[96:111]
    ds_read_b64_tr_b16 v[140:141], v59 offset:32768
    ds_read_b64_tr_b16 v[142:143], v59 offset:33024
    ds_read_b128 v[188:191], v43 offset:32768
    s_add_u32 m0, s75, 98304
    s_add_u32 s63, s61, s73
    buffer_load_dwordx4 v50, s[28:31], s63 offen lds
    v_and_b32 v5, 31, v1
    v_lshlrev_b32 v5, 2, v5
    s_lshl_b32 s60, s53, 7
    s_add_u32 s60, s60, 131584
    v_add_u32 v5, s60, v5
    ds_read2_b32 v[224:225], v5 offset0:0 offset1:128
    s_waitcnt lgkmcnt(0)
    v_mul_f32 v224, 0x3b000000, v224
    v_mul_f32 v228, 0x3b000000, v225
    v_fma_f32 v228, -v224, v224, v228
    v_max_f32 v228, 0, v228
    v_add_f32 v228, 0x3727c5ac, v228
    v_rsq_f32 v60, v228
    v_sqrt_f32 v229, v228
    v_sub_f32 v224, 0, v224
    v_cvt_pk_bf16_f32 v12, v224, v224
    v_and_b32 v225, 0xffff0000, v12
    v_sub_f32 v225, v224, v225
    v_cvt_pk_bf16_f32 v13, v225, v225
    v_cvt_pk_bf16_f32 v226, v229, v229
    v_and_b32 v226, 0xffff0000, v226
    v_sub_f32 v226, v229, v226
    v_cvt_pk_bf16_f32 v14, v229, v226
    v_mov_b32 v15, 0
    v_cmp_gt_u32 vcc, 32, v1
    v_subrev_u32 v5, 512, v5
    s_nop 0
    v_cndmask_b32 v12, 0, v12, vcc
    v_cndmask_b32 v13, 0, v13, vcc
    v_cndmask_b32 v14, 0, v14, vcc
    v_mul_f32 v32, 0x3fb8aa3b, v60
    v_mul_f32 v34, -2.0, v60
    v_mov_b32 v36, v60
    v_mul_f32 v38, 0x3eb8aa3b, v60
    ds_write_b32 v5, v60
    v_and_b32 v5, 31, v1
    v_lshlrev_b32 v5, 2, v5
    v_add_u32 v6, 134144, v5
    ds_read2_b32 v[232:233], v6 offset0:0 offset1:32
    ds_read2_b32 v[234:235], v6 offset0:64 offset1:96
    s_waitcnt lgkmcnt(0)
    v_add_f32 v232, v232, v233
    v_add_f32 v234, v234, v235
    v_add_f32 v232, v232, v234
    v_cvt_pk_bf16_f32 v233, v232, v232
    v_and_b32 v233, 0xffff0000, v233
    v_sub_f32 v233, v232, v233
    v_cvt_pk_bf16_f32 v16, v232, v233
    v_mov_b32 v17, v16
    v_lshl_or_b32 v18, v61, 16, v61
    v_mov_b32 v19, 0
    s_nop 1
    v_mfma_f32_32x32x16_bf16 v[64:79], v[16:19], v[12:15], v[64:79]
    s_cmp_eq_u32 s64, 0
    s_cbranch_scc1 gemm1_kernel_g1_x9
    v_and_b32 v5, 31, v1
    v_lshlrev_b32 v5, 2, v5
    v_add_u32 v6, 134656, v5
    ds_read2_b32 v[232:233], v6 offset0:0 offset1:32
    ds_read2_b32 v[234:235], v6 offset0:64 offset1:96
    s_waitcnt lgkmcnt(0)
    v_add_f32 v232, v232, v233
    v_add_f32 v234, v234, v235
    v_add_f32 v232, v232, v234
    v_cvt_pk_bf16_f32 v233, v232, v232
    v_and_b32 v233, 0xffff0000, v233
    v_sub_f32 v233, v232, v233
    v_cvt_pk_bf16_f32 v16, v232, v233
    v_mov_b32 v17, v16
    v_lshl_or_b32 v18, v62, 16, v62
    v_mov_b32 v19, 0
    s_nop 1
    v_mfma_f32_32x32x16_bf16 v[80:95], v[16:19], v[12:15], v[80:95]
gemm1_kernel_g1_x9:
    s_waitcnt vmcnt(3)
    s_barrier
    s_waitcnt lgkmcnt(0)
    v_mfma_f32_16x16x32_bf16 v[216:219], v[8:11], v[128:131], v[216:219]
    v_mul_f32 v224, v64, v32
    v_exp_f32 v224, v224
    v_mul_f32 v225, v65, v32
    v_exp_f32 v225, v225
    v_mul_f32 v226, v66, v32
    v_add_f32 v232, 2.0, v224
    v_exp_f32 v226, v226
    v_mfma_f32_32x32x16_bf16 v[96:111], v[176:179], v[128:131], v[96:111]
    v_mul_f32 v227, v67, v32
    v_fma_f32 v232, v224, v232, 2.0
    v_add_f32 v233, 2.0, v225
    v_exp_f32 v227, v227
    v_mul_f32 v228, v68, v32
    v_rcp_f32 v232, v232
    v_fma_f32 v233, v225, v233, 2.0
    ds_read_b64_tr_b16 v[128:129], v28 offset:0
    ds_read_b64_tr_b16 v[130:131], v28 offset:256
    ds_read_b128 v[160:163], v44 offset:0
    v_mfma_f32_32x32x16_bf16 v[96:111], v[180:183], v[132:135], v[96:111]
    v_add_f32 v234, 2.0, v226
    v_exp_f32 v228, v228
    v_mul_f32 v229, v69, v32
    v_rcp_f32 v233, v233
    v_fma_f32 v234, v226, v234, 2.0
    v_add_f32 v235, 2.0, v227
    v_exp_f32 v229, v229
    v_mul_f32 v230, v70, v32
    ds_read_b64_tr_b16 v[132:133], v29 offset:0
    ds_read_b64_tr_b16 v[134:135], v29 offset:256
    ds_read_b128 v[164:167], v45 offset:0
    s_lshl_b32 s60, s78, 7
    s_add_u32 s60, s60, s69
    s_mul_i32 s61, s78, 196608
    s_add_u32 s78, s78, 1
    s_and_b32 s78, s78, 7
    s_add_u32 m0, s70, 0
    s_add_u32 s63, s60, 7168
    buffer_load_dwordx4 v48, s[24:27], s60 offen lds
    buffer_load_dwordx4 v49, s[24:27], s63 offen offset:1024 lds
    v_mfma_f32_32x32x16_bf16 v[96:111], v[184:187], v[136:139], v[96:111]
    v_fma_f32 v232, v232, v34, v60
    v_rcp_f32 v234, v234
    v_fma_f32 v235, v227, v235, 2.0
    v_add_f32 v236, 2.0, v228
    v_exp_f32 v230, v230
    v_mul_f32 v231, v71, v32
    v_mul_f32 v64, v64, v232
    ds_read_b64_tr_b16 v[136:137], v30 offset:0
    ds_read_b64_tr_b16 v[138:139], v30 offset:256
    ds_read_b128 v[168:171], v46 offset:0
    v_mfma_f32_32x32x16_bf16 v[96:111], v[188:191], v[140:143], v[96:111]
    v_fma_f32 v233, v233, v34, v60
    v_rcp_f32 v235, v235
    v_fma_f32 v236, v228, v236, 2.0
    v_add_f32 v237, 2.0, v229
    v_exp_f32 v231, v231
    v_mul_f32 v224, v72, v32
    v_mul_f32 v65, v65, v233
    v_fma_f32 v234, v234, v34, v60
    ds_read_b64_tr_b16 v[140:141], v31 offset:0
    ds_read_b64_tr_b16 v[142:143], v31 offset:256
    ds_read_b128 v[172:175], v47 offset:0
    s_add_u32 m0, s75, 0
    s_add_u32 s63, s61, s73
    buffer_load_dwordx4 v50, s[28:31], s63 offen lds
    s_waitcnt vmcnt(3)
    s_barrier
    s_waitcnt lgkmcnt(0)
    v_mfma_f32_16x16x32_bf16 v[216:219], v[8:11], v[128:131], v[216:219]
    v_rcp_f32 v236, v236
    v_fma_f32 v237, v229, v237, 2.0
    v_add_f32 v238, 2.0, v230
    v_exp_f32 v224, v224
    v_mul_f32 v225, v73, v32
    v_cvt_pk_bf16_f32 v240, v64, v65
    v_mul_f32 v66, v66, v234
    v_mfma_f32_32x32x16_bf16 v[96:111], v[160:163], v[128:131], v[96:111]
    v_fma_f32 v235, v235, v34, v60
    v_rcp_f32 v237, v237
    v_fma_f32 v238, v230, v238, 2.0
    v_add_f32 v239, 2.0, v231
    v_exp_f32 v225, v225
    v_mul_f32 v226, v74, v32
    v_mul_f32 v67, v67, v235
    ds_read_b64_tr_b16 v[128:129], v28 offset:32768
    ds_read_b64_tr_b16 v[130:131], v28 offset:33024
    ds_read_b128 v[176:179], v44 offset:32768
    v_mfma_f32_32x32x16_bf16 v[96:111], v[164:167], v[132:135], v[96:111]
    v_fma_f32 v236, v236, v34, v60
    v_rcp_f32 v238, v238
    v_fma_f32 v239, v231, v239, 2.0
    v_add_f32 v232, 2.0, v224
    v_exp_f32 v226, v226
    v_mul_f32 v227, v75, v32
    v_cvt_pk_bf16_f32 v241, v66, v67
    v_mul_f32 v68, v68, v236
    ds_read_b64_tr_b16 v[132:133], v29 offset:32768
    ds_read_b64_tr_b16 v[134:135], v29 offset:33024
    ds_read_b128 v[180:183], v45 offset:32768
    s_lshl_b32 s60, s78, 7
    s_add_u32 s60, s60, s69
    s_mul_i32 s61, s78, 196608
    s_add_u32 s78, s78, 1
    s_and_b32 s78, s78, 7
    s_add_u32 m0, s70, 32768
    s_add_u32 s63, s60, 7168
    buffer_load_dwordx4 v48, s[24:27], s60 offen lds
    buffer_load_dwordx4 v49, s[24:27], s63 offen offset:1024 lds
    v_mfma_f32_32x32x16_bf16 v[96:111], v[168:171], v[136:139], v[96:111]
    v_fma_f32 v237, v237, v34, v60
    v_rcp_f32 v239, v239
    v_fma_f32 v232, v224, v232, 2.0
    v_add_f32 v233, 2.0, v225
    v_exp_f32 v227, v227
    v_mul_f32 v228, v76, v32
    v_mul_f32 v69, v69, v237
    ds_read_b64_tr_b16 v[136:137], v30 offset:32768
    ds_read_b64_tr_b16 v[138:139], v30 offset:33024
    ds_read_b128 v[184:187], v46 offset:32768
    v_mfma_f32_32x32x16_bf16 v[96:111], v[172:175], v[140:143], v[96:111]
    v_fma_f32 v238, v238, v34, v60
    v_rcp_f32 v232, v232
    v_fma_f32 v233, v225, v233, 2.0
    v_add_f32 v234, 2.0, v226
    v_exp_f32 v228, v228
    v_mul_f32 v229, v77, v32
    v_cvt_pk_bf16_f32 v242, v68, v69
    v_mul_f32 v70, v70, v238
    ds_read_b64_tr_b16 v[140:141], v31 offset:32768
    ds_read_b64_tr_b16 v[142:143], v31 offset:33024
    ds_read_b128 v[188:191], v47 offset:32768
    s_add_u32 m0, s75, 32768
    s_add_u32 s63, s61, s73
    buffer_load_dwordx4 v50, s[28:31], s63 offen lds
    s_waitcnt vmcnt(3)
    s_barrier
    s_waitcnt lgkmcnt(0)
    v_mfma_f32_16x16x32_bf16 v[216:219], v[8:11], v[128:131], v[216:219]
    v_fma_f32 v239, v239, v34, v60
    v_rcp_f32 v233, v233
    v_fma_f32 v234, v226, v234, 2.0
    v_add_f32 v235, 2.0, v227
    v_exp_f32 v229, v229
    v_mul_f32 v230, v78, v32
    v_mul_f32 v71, v71, v239
    v_mfma_f32_32x32x16_bf16 v[96:111], v[176:179], v[128:131], v[96:111]
    v_fma_f32 v232, v232, v34, v60
    v_rcp_f32 v234, v234
    v_fma_f32 v235, v227, v235, 2.0
    v_add_f32 v236, 2.0, v228
    v_exp_f32 v230, v230
    v_mul_f32 v231, v79, v32
    v_cvt_pk_bf16_f32 v243, v70, v71
    ds_read_b64_tr_b16 v[128:129], v56 offset:0
    ds_read_b64_tr_b16 v[130:131], v56 offset:256
    ds_read_b128 v[160:163], v40 offset:0
    v_mfma_f32_32x32x16_bf16 v[96:111], v[180:183], v[132:135], v[96:111]
    v_mul_f32 v72, v72, v232
    v_fma_f32 v233, v233, v34, v60
    v_rcp_f32 v235, v235
    v_fma_f32 v236, v228, v236, 2.0
    v_add_f32 v237, 2.0, v229
    v_exp_f32 v231, v231
    v_mul_f32 v73, v73, v233
    v_fma_f32 v234, v234, v34, v60
    ds_read_b64_tr_b16 v[132:133], v57 offset:0
    ds_read_b64_tr_b16 v[134:135], v57 offset:256
    ds_read_b128 v[164:167], v41 offset:0
    s_lshl_b32 s60, s78, 7
    s_add_u32 s60, s60, s69
    s_mul_i32 s61, s78, 196608
    s_add_u32 s78, s78, 1
    s_and_b32 s78, s78, 7
    s_add_u32 m0, s70, 65536
    s_add_u32 s63, s60, 7168
    buffer_load_dwordx4 v48, s[24:27], s60 offen lds
    buffer_load_dwordx4 v49, s[24:27], s63 offen offset:1024 lds
    v_mfma_f32_32x32x16_bf16 v[96:111], v[184:187], v[136:139], v[96:111]
    v_rcp_f32 v236, v236
    v_fma_f32 v237, v229, v237, 2.0
    v_add_f32 v238, 2.0, v230
    v_cvt_pk_bf16_f32 v244, v72, v73
    v_mul_f32 v74, v74, v234
    v_fma_f32 v235, v235, v34, v60
    v_rcp_f32 v237, v237
    ds_read_b64_tr_b16 v[136:137], v58 offset:0
    ds_read_b64_tr_b16 v[138:139], v58 offset:256
    ds_read_b128 v[168:171], v42 offset:0
    v_mfma_f32_32x32x16_bf16 v[96:111], v[188:191], v[140:143], v[96:111]
    v_fma_f32 v238, v230, v238, 2.0
    v_add_f32 v239, 2.0, v231
    v_mul_f32 v75, v75, v235
    v_fma_f32 v236, v236, v34, v60
    v_rcp_f32 v238, v238
    v_fma_f32 v239, v231, v239, 2.0
    v_cvt_pk_bf16_f32 v245, v74, v75
    v_mul_f32 v76, v76, v236
    ds_read_b64_tr_b16 v[140:141], v59 offset:0
    ds_read_b64_tr_b16 v[142:143], v59 offset:256
    ds_read_b128 v[172:175], v43 offset:0
    s_add_u32 m0, s75, 65536
    s_add_u32 s63, s61, s73
    buffer_load_dwordx4 v50, s[28:31], s63 offen lds
    s_waitcnt vmcnt(3)
    s_barrier
    s_waitcnt lgkmcnt(0)
    v_mfma_f32_16x16x32_bf16 v[216:219], v[8:11], v[128:131], v[216:219]
    v_fma_f32 v237, v237, v34, v60
    v_rcp_f32 v239, v239
    v_mul_f32 v77, v77, v237
    v_fma_f32 v238, v238, v34, v60
    v_cvt_pk_bf16_f32 v246, v76, v77
    v_mul_f32 v78, v78, v238
    v_fma_f32 v239, v239, v34, v60
    v_mfma_f32_32x32x16_bf16 v[96:111], v[160:163], v[128:131], v[96:111]
    v_mul_f32 v79, v79, v239
    v_cvt_pk_bf16_f32 v247, v78, v79
    s_mul_i32 s67, s58, 112
    s_add_u32 s68, s57, 2
    s_lshl_b32 s68, s68, 1
    s_add_u32 s67, s67, s68
    s_lshl_b32 s67, s67, 10
    ds_read_b64_tr_b16 v[128:129], v56 offset:32768
    ds_read_b64_tr_b16 v[130:131], v56 offset:33024
    ds_read_b128 v[176:179], v40 offset:32768
    v_mfma_f32_32x32x16_bf16 v[96:111], v[164:167], v[132:135], v[96:111]
    s_add_u32 s67, s67, 8388608
    buffer_store_dwordx4 v[240:243], v2, s[36:39], s67 offen sc1
    buffer_store_dwordx4 v[244:247], v2, s[36:39], s67 offen offset:1024 sc1
    v_mul_f32 v224, v80, v32
    v_exp_f32 v224, v224
    v_mul_f32 v225, v81, v32
    v_exp_f32 v225, v225
    v_mul_f32 v226, v82, v32
    ds_read_b64_tr_b16 v[132:133], v57 offset:32768
    ds_read_b64_tr_b16 v[134:135], v57 offset:33024
    ds_read_b128 v[180:183], v41 offset:32768
    s_lshl_b32 s60, s78, 7
    s_add_u32 s60, s60, s69
    s_mul_i32 s61, s78, 196608
    s_add_u32 s78, s78, 1
    s_and_b32 s78, s78, 7
    s_add_u32 m0, s70, 98304
    s_add_u32 s63, s60, 7168
    buffer_load_dwordx4 v48, s[24:27], s60 offen lds
    buffer_load_dwordx4 v49, s[24:27], s63 offen offset:1024 lds
    v_mfma_f32_32x32x16_bf16 v[96:111], v[168:171], v[136:139], v[96:111]
    v_add_f32 v232, 2.0, v224
    v_exp_f32 v226, v226
    v_mul_f32 v227, v83, v32
    v_fma_f32 v232, v224, v232, 2.0
    v_add_f32 v233, 2.0, v225
    v_exp_f32 v227, v227
    v_mul_f32 v228, v84, v32
    ds_read_b64_tr_b16 v[136:137], v58 offset:32768
    ds_read_b64_tr_b16 v[138:139], v58 offset:33024
    ds_read_b128 v[184:187], v42 offset:32768
    v_mfma_f32_32x32x16_bf16 v[96:111], v[172:175], v[140:143], v[96:111]
    v_rcp_f32 v232, v232
    v_fma_f32 v233, v225, v233, 2.0
    v_add_f32 v234, 2.0, v226
    v_exp_f32 v228, v228
    v_mul_f32 v229, v85, v32
    v_rcp_f32 v233, v233
    v_fma_f32 v234, v226, v234, 2.0
    v_add_f32 v235, 2.0, v227
    ds_read_b64_tr_b16 v[140:141], v59 offset:32768
    ds_read_b64_tr_b16 v[142:143], v59 offset:33024
    ds_read_b128 v[188:191], v43 offset:32768
    s_add_u32 m0, s75, 98304
    s_add_u32 s63, s61, s73
    buffer_load_dwordx4 v50, s[28:31], s63 offen lds
    s_waitcnt vmcnt(5)
    s_barrier
    s_waitcnt lgkmcnt(0)
    v_mfma_f32_16x16x32_bf16 v[216:219], v[8:11], v[128:131], v[216:219]
    v_exp_f32 v229, v229
    v_mul_f32 v230, v86, v32
    v_fma_f32 v232, v232, v34, v60
    v_rcp_f32 v234, v234
    v_fma_f32 v235, v227, v235, 2.0
    v_add_f32 v236, 2.0, v228
    v_exp_f32 v230, v230
    v_mfma_f32_32x32x16_bf16 v[96:111], v[176:179], v[128:131], v[96:111]
    v_mul_f32 v231, v87, v32
    v_mul_f32 v80, v80, v232
    v_fma_f32 v233, v233, v34, v60
    v_rcp_f32 v235, v235
    v_fma_f32 v236, v228, v236, 2.0
    v_add_f32 v237, 2.0, v229
    v_exp_f32 v231, v231
    ds_read_b64_tr_b16 v[128:129], v28 offset:0
    ds_read_b64_tr_b16 v[130:131], v28 offset:256
    ds_read_b128 v[160:163], v44 offset:0
    v_mfma_f32_32x32x16_bf16 v[96:111], v[180:183], v[132:135], v[96:111]
    v_mul_f32 v224, v88, v32
    v_mul_f32 v81, v81, v233
    v_fma_f32 v234, v234, v34, v60
    v_rcp_f32 v236, v236
    v_fma_f32 v237, v229, v237, 2.0
    v_add_f32 v238, 2.0, v230
    v_exp_f32 v224, v224
    v_mul_f32 v225, v89, v32
    ds_read_b64_tr_b16 v[132:133], v29 offset:0
    ds_read_b64_tr_b16 v[134:135], v29 offset:256
    ds_read_b128 v[164:167], v45 offset:0
    v_mfma_f32_32x32x16_bf16 v[96:111], v[184:187], v[136:139], v[96:111]
    v_cvt_pk_bf16_f32 v248, v80, v81
    v_mul_f32 v82, v82, v234
    v_fma_f32 v235, v235, v34, v60
    v_rcp_f32 v237, v237
    v_fma_f32 v238, v230, v238, 2.0
    v_add_f32 v239, 2.0, v231
    v_exp_f32 v225, v225
    ds_read_b64_tr_b16 v[136:137], v30 offset:0
    ds_read_b64_tr_b16 v[138:139], v30 offset:256
    ds_read_b128 v[168:171], v46 offset:0
    v_mfma_f32_32x32x16_bf16 v[96:111], v[188:191], v[140:143], v[96:111]
    v_mul_f32 v226, v90, v32
    v_mul_f32 v83, v83, v235
    v_fma_f32 v236, v236, v34, v60
    v_rcp_f32 v238, v238
    v_fma_f32 v239, v231, v239, 2.0
    v_add_f32 v232, 2.0, v224
    v_exp_f32 v226, v226
    v_mul_f32 v227, v91, v32
    ds_read_b64_tr_b16 v[140:141], v31 offset:0
    ds_read_b64_tr_b16 v[142:143], v31 offset:256
    ds_read_b128 v[172:175], v47 offset:0
    s_waitcnt vmcnt(0)
    s_barrier
    s_waitcnt lgkmcnt(0)
    v_mfma_f32_16x16x32_bf16 v[216:219], v[8:11], v[128:131], v[216:219]
    v_cvt_pk_bf16_f32 v249, v82, v83
    v_mul_f32 v84, v84, v236
    v_fma_f32 v237, v237, v34, v60
    v_rcp_f32 v239, v239
    v_fma_f32 v232, v224, v232, 2.0
    v_add_f32 v233, 2.0, v225
    v_exp_f32 v227, v227
    v_mfma_f32_32x32x16_bf16 v[96:111], v[160:163], v[128:131], v[96:111]
    v_mul_f32 v228, v92, v32
    v_mul_f32 v85, v85, v237
    v_fma_f32 v238, v238, v34, v60
    v_rcp_f32 v232, v232
    v_fma_f32 v233, v225, v233, 2.0
    v_add_f32 v234, 2.0, v226
    v_exp_f32 v228, v228
    ds_read_b64_tr_b16 v[128:129], v28 offset:32768
    ds_read_b64_tr_b16 v[130:131], v28 offset:33024
    ds_read_b128 v[176:179], v44 offset:32768
    v_mfma_f32_32x32x16_bf16 v[96:111], v[164:167], v[132:135], v[96:111]
    v_mul_f32 v229, v93, v32
    v_cvt_pk_bf16_f32 v250, v84, v85
    v_mul_f32 v86, v86, v238
    v_fma_f32 v239, v239, v34, v60
    v_rcp_f32 v233, v233
    v_fma_f32 v234, v226, v234, 2.0
    v_add_f32 v235, 2.0, v227
    v_exp_f32 v229, v229
    ds_read_b64_tr_b16 v[132:133], v29 offset:32768
    ds_read_b64_tr_b16 v[134:135], v29 offset:33024
    ds_read_b128 v[180:183], v45 offset:32768
    v_mfma_f32_32x32x16_bf16 v[96:111], v[168:171], v[136:139], v[96:111]
    v_mul_f32 v230, v94, v32
    v_mul_f32 v87, v87, v239
    v_fma_f32 v232, v232, v34, v60
    v_rcp_f32 v234, v234
    v_fma_f32 v235, v227, v235, 2.0
    v_add_f32 v236, 2.0, v228
    v_exp_f32 v230, v230
    ds_read_b64_tr_b16 v[136:137], v30 offset:32768
    ds_read_b64_tr_b16 v[138:139], v30 offset:33024
    ds_read_b128 v[184:187], v46 offset:32768
    v_mfma_f32_32x32x16_bf16 v[96:111], v[172:175], v[140:143], v[96:111]
    v_mul_f32 v231, v95, v32
    v_cvt_pk_bf16_f32 v251, v86, v87
    v_mul_f32 v88, v88, v232
    v_fma_f32 v233, v233, v34, v60
    v_rcp_f32 v235, v235
    v_fma_f32 v236, v228, v236, 2.0
    v_add_f32 v237, 2.0, v229
    v_exp_f32 v231, v231
    ds_read_b64_tr_b16 v[140:141], v31 offset:32768
    ds_read_b64_tr_b16 v[142:143], v31 offset:33024
    ds_read_b128 v[188:191], v47 offset:32768
    s_waitcnt lgkmcnt(0)
    v_mfma_f32_16x16x32_bf16 v[216:219], v[8:11], v[128:131], v[216:219]
    v_mul_f32 v89, v89, v233
    v_fma_f32 v234, v234, v34, v60
    v_rcp_f32 v236, v236
    v_fma_f32 v237, v229, v237, 2.0
    v_add_f32 v238, 2.0, v230
    v_cvt_pk_bf16_f32 v252, v88, v89
    v_mul_f32 v90, v90, v234
    v_mfma_f32_32x32x16_bf16 v[96:111], v[176:179], v[128:131], v[96:111]
    v_fma_f32 v235, v235, v34, v60
    v_rcp_f32 v237, v237
    v_fma_f32 v238, v230, v238, 2.0
    v_add_f32 v239, 2.0, v231
    v_mul_f32 v91, v91, v235
    v_fma_f32 v236, v236, v34, v60
    v_rcp_f32 v238, v238
    v_mfma_f32_32x32x16_bf16 v[96:111], v[180:183], v[132:135], v[96:111]
    v_fma_f32 v239, v231, v239, 2.0
    v_cvt_pk_bf16_f32 v253, v90, v91
    v_mul_f32 v92, v92, v236
    v_fma_f32 v237, v237, v34, v60
    v_rcp_f32 v239, v239
    v_mul_f32 v93, v93, v237
    v_fma_f32 v238, v238, v34, v60
    v_cvt_pk_bf16_f32 v254, v92, v93
    v_mfma_f32_32x32x16_bf16 v[96:111], v[184:187], v[136:139], v[96:111]
    v_mul_f32 v94, v94, v238
    v_fma_f32 v239, v239, v34, v60
    v_mul_f32 v95, v95, v239
    v_cvt_pk_bf16_f32 v255, v94, v95
    s_mul_i32 s67, s58, 112
    s_add_u32 s68, s57, 3
    s_lshl_b32 s68, s68, 1
    v_mfma_f32_32x32x16_bf16 v[96:111], v[188:191], v[140:143], v[96:111]
    s_add_u32 s67, s67, s68
    s_lshl_b32 s67, s67, 10
    s_add_u32 s67, s67, 8388608
    s_xor_b32 s68, s64, 1
    s_mul_i32 s68, s68, 0x7f000000
    s_add_u32 s67, s67, s68
    buffer_store_dwordx4 v[248:251], v2, s[36:39], s67 offen sc1
    buffer_store_dwordx4 v[252:255], v2, s[36:39], s67 offen offset:1024 sc1
    s_nop 7
    s_lshl_b32 s60, s53, 7
    v_lshlrev_b32 v5, 2, v1
    v_add_u32 v5, s60, v5
    v_add_u32 v5, 136192, v5
    s_mov_b64 exec, 0xffff
    v_add_u32 v6, 0, v5
    ds_write2_b32 v6, v216, v217 offset0:0 offset1:16
    s_mov_b64 exec, -1
    s_waitcnt lgkmcnt(0)
    s_barrier
    v_and_b32 v5, 31, v1
    v_lshlrev_b32 v5, 2, v5
    v_add_u32 v6, 136192, v5
    ds_read2_b32 v[232:233], v6 offset0:0 offset1:32
    ds_read2_b32 v[234:235], v6 offset0:64 offset1:96
    s_waitcnt lgkmcnt(0)
    v_add_f32 v232, v232, v233
    v_add_f32 v234, v234, v235
    v_add_f32 v232, v232, v234
    v_cvt_pk_bf16_f32 v233, v232, v232
    v_and_b32 v233, 0xffff0000, v233
    v_sub_f32 v233, v232, v233
    v_cvt_pk_bf16_f32 v16, v232, v233
    v_mov_b32 v17, v16
    v_mov_b32 v18, 0
    v_mov_b32 v19, 0
    s_nop 1
    v_mfma_f32_32x32x16_bf16 v[96:111], v[12:15], v[16:19], v[96:111]
    v_lshrrev_b32 v5, 5, v1
    v_lshlrev_b32 v5, 4, v5
    s_lshl_b32 s60, s53, 7
    s_add_u32 s60, s60, 131072
    v_add_u32 v5, s60, v5
    ds_read_b128 v[144:147], v5 offset:0
    ds_read_b128 v[148:151], v5 offset:32
    ds_read_b128 v[152:155], v5 offset:64
    ds_read_b128 v[156:159], v5 offset:96
    s_waitcnt lgkmcnt(0)
    s_nop 9
    v_pk_mul_f32 v[96:97], v[96:97], v[144:145]
    v_pk_mul_f32 v[98:99], v[98:99], v[146:147]
    v_pk_mul_f32 v[100:101], v[100:101], v[148:149]
    v_pk_mul_f32 v[102:103], v[102:103], v[150:151]
    v_pk_mul_f32 v[104:105], v[104:105], v[152:153]
    v_pk_mul_f32 v[106:107], v[106:107], v[154:155]
    v_pk_mul_f32 v[108:109], v[108:109], v[156:157]
    v_pk_mul_f32 v[110:111], v[110:111], v[158:159]
    v_cvt_pk_bf16_f32 v128, v96, v97
    v_cvt_pk_bf16_f32 v129, v98, v99
    v_cvt_pk_bf16_f32 v130, v100, v101
    v_cvt_pk_bf16_f32 v131, v102, v103
    v_cvt_pk_bf16_f32 v132, v104, v105
    v_cvt_pk_bf16_f32 v133, v106, v107
    v_cvt_pk_bf16_f32 v134, v108, v109
    v_cvt_pk_bf16_f32 v135, v110, v111
    s_lshl_b32 s60, s56, 17
    s_lshl_b32 s61, s58, 10
    s_add_u32 s60, s60, s61
    s_add_u32 s60, s60, 4194304
    buffer_store_dwordx4 v[128:131], v53, s[36:39], s60 offen sc1
    buffer_store_dwordx4 v[132:135], v53, s[36:39], s60 offen offset:512 sc1
    s_branch gemm1_kernel_done
gemm1_kernel_done:
gemm1_kernel_end:
    s_endpgm
.text
.globl attn_kernel
.p2align 8
.type attn_kernel,@function
attn_kernel:

    s_cmp_ge_u32 s2, 256
    s_cbranch_scc1 attn_kernel_end
    s_load_dwordx2 s[4:5], s[0:1], 72
    s_load_dwordx2 s[6:7], s[0:1], 0
    s_load_dwordx4 s[44:47], s[0:1], 56
    s_getreg_b32 s49, hwreg(HW_REG_XCC_ID)
    v_and_b32 v1, 63, v0
    v_lshrrev_b32 v5, 6, v0
    v_lshlrev_b32 v2, 4, v1
    v_readfirstlane_b32 s12, v5
    s_and_b32 s49, s49, 7
    v_mov_b32 v232, 131072
    s_waitcnt lgkmcnt(0)
    s_and_b32 s15, s2, 7
    s_lshr_b32 s16, s2, 3
    s_and_b32 s17, s16, 3
    s_lshl_b32 s13, s15, 2
    s_add_u32 s13, s13, s17
    s_lshr_b32 s17, s16, 2
    s_and_b32 s24, s12, 3
    s_lshr_b32 s25, s12, 2
    s_lshl_b32 s14, s17, 3
    s_lshl_b32 s26, s24, 1
    s_add_u32 s14, s14, s26
    s_lshl_b32 s18, s13, 16
    s_mov_b32 s10, 268435456
    s_mov_b32 s11, 0x20000
    s_mov_b32 s20, 0xffff
    s_mov_b32 s21, 0xffff
    s_mov_b32 s30, 268435456
    s_mov_b32 s31, 0x20000
    s_and_b32 s26, s12, 1
    s_lshl_b32 s27, s13, 1
    s_add_u32 s27, s27, s26
    s_lshl_b32 s33, s17, 1
    s_lshr_b32 s48, s12, 1
    s_mul_i32 s26, s48, 28672
    s_mul_i32 s34, s27, 114688
    s_add_u32 s34, s34, s26
    s_add_u32 s34, s34, 8388608
    s_mul_i32 s35, s33, 114688
    s_add_u32 s35, s35, s26
    s_add_u32 s35, s35, 16777216
    s_add_u32 s36, s35, 114688
    s_lshl_b32 s40, s33, 15
    s_lshl_b32 s41, s48, 13
    s_add_u32 s40, s40, s41
    s_add_u32 s40, s40, 18874368
    s_add_u32 s41, s40, 32768
    s_add_u32 s42, s40, 4096
    s_add_u32 s43, s41, 4096
    s_waitcnt lgkmcnt(0)
    s_mov_b32 s8, s4
    s_and_b32 s9, s5, 0xffff
    s_mov_b32 s28, s4
    s_and_b32 s29, s5, 0xffff
    s_lshl_b32 s15, s14, 10
    s_add_u32 s15, s15, s18
    buffer_load_dwordx4 v[8:11], v2, s[8:11], s15 offen
    buffer_load_dwordx4 v[12:15], v2, s[8:11], s15 offen offset:1024
    s_mul_i32 s15, s24, 3072
    s_lshl_b32 s16, s25, 16
    s_add_u32 s15, s15, s16
    s_mov_b32 m0, s15
    s_mul_i32 s17, s25, 2031616
    s_add_u32 s17, s17, s15
    s_add_u32 s17, s17, s18
    s_add_u32 s17, s17, 2097152
    buffer_load_dwordx4 v2, s[8:11], s17 offen lds
    buffer_load_dwordx4 v2, s[8:11], s17 offen offset:1024 lds
    buffer_load_dwordx4 v2, s[8:11], s17 offen offset:2048 lds
    s_lshl_b32 s15, s25, 15
    v_add_u32 v3, s15, v2
    v_lshrrev_b32 v5, 5, v1
    v_lshlrev_b32 v5, 8, v5
    v_and_b32 v6, 15, v1
    v_lshlrev_b32 v6, 4, v6
    v_add_u32 v4, v5, v6
    s_add_u32 s15, s15, 0x10000
    v_add_u32 v4, s15, v4
    v_mov_b32 v232, 131072
    v_mov_b32 v233, 0
    ds_write_b32 v232, v233
    ds_write_b32 v232, v233 offset:4
    ds_write_b32 v232, v233 offset:12
    v_mov_b32 v233, 1
    v_mov_b32 v136, 0x3f803f80
    v_mov_b32 v137, 0x3f803f80
    v_mov_b32 v138, 0x3f803f80
    v_mov_b32 v139, 0x3f803f80
    v_mov_b32 v140, 0x3f803f80
    v_mov_b32 v141, 0x3f803f80
    v_mov_b32 v142, 0x3f803f80
    v_mov_b32 v143, 0x3f803f80
    v_mov_b32 v144, 0x3f803f80
    v_mov_b32 v145, 0x3f803f80
    v_mov_b32 v146, 0x3f803f80
    v_mov_b32 v147, 0x3f803f80
    v_mov_b32 v148, 0x3f803f80
    v_mov_b32 v149, 0x3f803f80
    v_mov_b32 v150, 0x3f803f80
    v_mov_b32 v151, 0x3f803f80
    v_mov_b32 v96, 0
    v_mov_b32 v97, 0
    v_mov_b32 v98, 0
    v_mov_b32 v99, 0
    v_mov_b32 v100, 0
    v_mov_b32 v101, 0
    v_mov_b32 v102, 0
    v_mov_b32 v103, 0
    v_mov_b32 v104, 0
    v_mov_b32 v105, 0
    v_mov_b32 v106, 0
    v_mov_b32 v107, 0
    v_mov_b32 v108, 0
    v_mov_b32 v109, 0
    v_mov_b32 v110, 0
    v_mov_b32 v111, 0
    v_mov_b32 v112, 0
    v_mov_b32 v113, 0
    v_mov_b32 v114, 0
    v_mov_b32 v115, 0
    v_mov_b32 v116, 0
    v_mov_b32 v117, 0
    v_mov_b32 v118, 0
    v_mov_b32 v119, 0
    v_mov_b32 v120, 0
    v_mov_b32 v121, 0
    v_mov_b32 v122, 0
    v_mov_b32 v123, 0
    v_mov_b32 v124, 0
    v_mov_b32 v125, 0
    v_mov_b32 v126, 0
    v_mov_b32 v127, 0
    v_mov_b32 v80, 0
    v_mov_b32 v81, 0
    v_mov_b32 v82, 0
    v_mov_b32 v83, 0
    v_mov_b32 v84, 0
    v_mov_b32 v85, 0
    v_mov_b32 v86, 0
    v_mov_b32 v87, 0
    v_mov_b32 v88, 0
    v_mov_b32 v89, 0
    v_mov_b32 v90, 0
    v_mov_b32 v91, 0
    v_mov_b32 v92, 0
    v_mov_b32 v93, 0
    v_mov_b32 v94, 0
    v_mov_b32 v95, 0
    v_mov_b32 v152, 0
    v_mov_b32 v153, 0
    v_mov_b32 v154, 0
    v_mov_b32 v155, 0
    v_mov_b32 v156, 0
    v_mov_b32 v157, 0
    v_mov_b32 v158, 0
    v_mov_b32 v159, 0
    v_mov_b32 v160, 0
    v_mov_b32 v161, 0
    v_mov_b32 v162, 0
    v_mov_b32 v163, 0
    v_mov_b32 v164, 0
    v_mov_b32 v165, 0
    v_mov_b32 v166, 0
    v_mov_b32 v167, 0
    v_mov_b32 v168, 0
    v_mov_b32 v169, 0
    v_mov_b32 v170, 0
    v_mov_b32 v171, 0
    v_mov_b32 v172, 0
    v_mov_b32 v173, 0
    v_mov_b32 v174, 0
    v_mov_b32 v175, 0
    v_mov_b32 v176, 0
    v_mov_b32 v177, 0
    v_mov_b32 v178, 0
    v_mov_b32 v179, 0
    v_mov_b32 v180, 0
    v_mov_b32 v181, 0
    v_mov_b32 v182, 0
    v_mov_b32 v183, 0
    v_mov_b32 v184, 0
    v_mov_b32 v185, 0
    v_mov_b32 v186, 0
    v_mov_b32 v187, 0
    v_mov_b32 v188, 0
    v_mov_b32 v189, 0
    v_mov_b32 v190, 0
    v_mov_b32 v191, 0
    v_mov_b32 v192, 0
    v_mov_b32 v193, 0
    v_mov_b32 v194, 0
    v_mov_b32 v195, 0
    v_mov_b32 v196, 0
    v_mov_b32 v197, 0
    v_mov_b32 v198, 0
    v_mov_b32 v199, 0
    v_mov_b32 v200, 0
    v_mov_b32 v201, 0
    v_mov_b32 v202, 0
    v_mov_b32 v203, 0
    v_mov_b32 v204, 0
    v_mov_b32 v205, 0
    v_mov_b32 v206, 0
    v_mov_b32 v207, 0
    v_mov_b32 v208, 0
    v_mov_b32 v209, 0
    v_mov_b32 v210, 0
    v_mov_b32 v211, 0
    v_mov_b32 v212, 0
    v_mov_b32 v213, 0
    v_mov_b32 v214, 0
    v_mov_b32 v215, 0
    v_mov_b32 v216, 0
    v_mov_b32 v217, 0
    v_mov_b32 v218, 0
    v_mov_b32 v219, 0
    v_mov_b32 v220, 0
    v_mov_b32 v221, 0
    v_mov_b32 v222, 0
    v_mov_b32 v223, 0
    v_mov_b32 v224, 0
    v_mov_b32 v225, 0
    v_mov_b32 v226, 0
    v_mov_b32 v227, 0
    v_mov_b32 v228, 0
    v_mov_b32 v229, 0
    v_mov_b32 v230, 0
    v_mov_b32 v231, 0
    s_waitcnt vmcnt(0) lgkmcnt(0)
    s_barrier
    s_cmp_eq_u32 s25, 0
    s_cbranch_scc1 attn_kernel_nold
    s_mul_i32 s15, s24, 3072
    s_add_u32 s15, s15, 32768
    s_add_u32 s17, s15, s18
    s_add_u32 s17, s17, 2097152
    s_add_u32 s19, s15, 0
    s_mov_b32 m0, s19
    s_add_u32 s19, s19, 4096
    buffer_load_dwordx4 v2, s[8:11], s17 offen offset:0 lds
    buffer_load_dwordx4 v2, s[8:11], s17 offen offset:1024 lds
    buffer_load_dwordx4 v2, s[8:11], s17 offen offset:2048 lds
    s_add_u32 s17, s17, 4096
    s_mul_i32 s15, s24, 3072
    s_add_u32 s15, s15, 32768
    s_add_u32 s17, s15, s18
    s_add_u32 s17, s17, 4194304
    s_add_u32 s19, s15, 65536
    s_mov_b32 m0, s19
    s_add_u32 s19, s19, 4096
    buffer_load_dwordx4 v2, s[8:11], s17 offen offset:0 lds
    buffer_load_dwordx4 v2, s[8:11], s17 offen offset:1024 lds
    buffer_load_dwordx4 v2, s[8:11], s17 offen offset:2048 lds
    s_add_u32 s17, s17, 4096
    s_mul_i32 s15, s24, 5120
    s_add_u32 s15, s15, 12288
    s_add_u32 s17, s15, s18
    s_add_u32 s17, s17, 2097152
    s_add_u32 s19, s15, 0
    s_mov_b32 m0, s19
    s_add_u32 s19, s19, 4096
    buffer_load_dwordx4 v2, s[8:11], s17 offen offset:0 lds
    buffer_load_dwordx4 v2, s[8:11], s17 offen offset:1024 lds
    buffer_load_dwordx4 v2, s[8:11], s17 offen offset:2048 lds
    buffer_load_dwordx4 v2, s[8:11], s17 offen offset:3072 lds
    s_add_u32 s17, s17, 4096
    s_mov_b32 m0, s19
    s_add_u32 s19, s19, 4096
    buffer_load_dwordx4 v2, s[8:11], s17 offen offset:0 lds
    s_add_u32 s17, s17, 4096
    s_mul_i32 s15, s24, 5120
    s_add_u32 s15, s15, 12288
    s_add_u32 s17, s15, s18
    s_add_u32 s17, s17, 4194304
    s_add_u32 s19, s15, 65536
    s_mov_b32 m0, s19
    s_add_u32 s19, s19, 4096
    buffer_load_dwordx4 v2, s[8:11], s17 offen offset:0 lds
    buffer_load_dwordx4 v2, s[8:11], s17 offen offset:1024 lds
    buffer_load_dwordx4 v2, s[8:11], s17 offen offset:2048 lds
    buffer_load_dwordx4 v2, s[8:11], s17 offen offset:3072 lds
    s_add_u32 s17, s17, 4096
    s_mov_b32 m0, s19
    s_add_u32 s19, s19, 4096
    buffer_load_dwordx4 v2, s[8:11], s17 offen offset:0 lds
    s_add_u32 s17, s17, 4096
    s_waitcnt vmcnt(10)
    s_mov_b64 exec, 1
    ds_add_u32 v232, v233 offset:4
    s_mov_b64 exec, -1
attn_kernel_pollb:
    ds_read_b32 v234, v232 offset:4
    s_waitcnt lgkmcnt(0)
    v_readfirstlane_b32 s38, v234
    s_cmp_ge_u32 s38, 4
    s_cbranch_scc1 attn_kernel_pollbd
    s_sleep 2
    s_branch attn_kernel_pollb
attn_kernel_pollbd:
attn_kernel_nold:
    ds_read_b128 v[128:131], v3
    ds_read_b128 v[132:135], v3 offset:1024
    s_mov_b64 exec, s[20:21]
    ds_read_b128 v[136:139], v4
    ds_read_b128 v[140:143], v4 offset:512
    s_mov_b64 exec, -1
    s_waitcnt lgkmcnt(3)
    v_mfma_f32_32x32x16_bf16 v[48:63], v[128:131], v[8:11], 0
    v_mfma_f32_32x32x16_bf16 v[64:79], v[128:131], v[12:15], 0
    s_nop 15
    s_nop 3
    v_max3_f32 v5, v48, v49, v50
    v_max3_f32 v5, v5, v51, v52
    v_max3_f32 v5, v5, v53, v54
    v_max3_f32 v5, v5, v55, v56
    v_max3_f32 v5, v5, v57, v58
    v_max3_f32 v5, v5, v59, v60
    v_max3_f32 v5, v5, v61, v62
    v_max_f32 v5, v5, v63
    s_nop 0
    v_mov_b32 v6, v5
    s_nop 1
    v_permlane32_swap_b32 v5, v6
    s_nop 1
    v_max_f32 v5, v5, v6
    v_sub_f32 v5, 0, v5
    v_mov_b32 v16, v5
    v_mov_b32 v17, v5
    v_mov_b32 v18, v5
    v_mov_b32 v19, v5
    v_mov_b32 v20, v5
    v_mov_b32 v21, v5
    v_mov_b32 v22, v5
    v_mov_b32 v23, v5
    v_mov_b32 v24, v5
    v_mov_b32 v25, v5
    v_mov_b32 v26, v5
    v_mov_b32 v27, v5
    v_mov_b32 v28, v5
    v_mov_b32 v29, v5
    v_mov_b32 v30, v5
    v_mov_b32 v31, v5
    s_nop 7
    v_max3_f32 v5, v64, v65, v66
    v_max3_f32 v5, v5, v67, v68
    v_max3_f32 v5, v5, v69, v70
    v_max3_f32 v5, v5, v71, v72
    v_max3_f32 v5, v5, v73, v74
    v_max3_f32 v5, v5, v75, v76
    v_max3_f32 v5, v5, v77, v78
    v_max_f32 v5, v5, v79
    v_mfma_f32_32x32x16_bf16 v[48:63], v[128:131], v[8:11], v[16:31]
    s_nop 0
    v_mov_b32 v6, v5
    s_nop 1
    v_permlane32_swap_b32 v5, v6
    s_nop 1
    v_max_f32 v5, v5, v6
    v_sub_f32 v5, 0, v5
    v_mov_b32 v32, v5
    v_mov_b32 v33, v5
    v_mov_b32 v34, v5
    v_mov_b32 v35, v5
    v_mov_b32 v36, v5
    v_mov_b32 v37, v5
    v_mov_b32 v38, v5
    v_mov_b32 v39, v5
    v_mov_b32 v40, v5
    v_mov_b32 v41, v5
    v_mov_b32 v42, v5
    v_mov_b32 v43, v5
    v_mov_b32 v44, v5
    v_mov_b32 v45, v5
    v_mov_b32 v46, v5
    v_mov_b32 v47, v5
    s_mov_b32 s22, 0
    s_cmp_eq_u32 s25, 0
    s_cbranch_scc1 attn_kernel_nfa
    s_waitcnt vmcnt(0)
    s_mov_b64 exec, 1
    ds_add_u32 v232, v233
    s_mov_b64 exec, -1
attn_kernel_nfa:
    s_lshl_b32 s39, s25, 2
    s_lshl_b32 s38, s25, 3
    s_add_u32 s39, s39, s38
    v_add_u32 v237, s39, v232
    s_setprio 3
attn_kernel_loop:
    s_cmp_gt_u32 s22, 2
    s_cbranch_scc1 attn_kernel_nobar
    s_cmp_eq_u32 s22, 2
    s_cbranch_scc1 attn_kernel_polla
    s_cmp_eq_u32 s25, 0
    s_cbranch_scc1 attn_kernel_nobar
    s_cmp_eq_u32 s22, 0
    s_cbranch_scc0 attn_kernel_it1
    s_mul_i32 s15, s24, 5120
    s_add_u32 s15, s15, 45056
    s_add_u32 s17, s15, s18
    s_add_u32 s17, s17, 2097152
    s_add_u32 s19, s15, 0
    s_mov_b32 m0, s19
    s_add_u32 s19, s19, 4096
    buffer_load_dwordx4 v2, s[8:11], s17 offen offset:0 lds
    buffer_load_dwordx4 v2, s[8:11], s17 offen offset:1024 lds
    buffer_load_dwordx4 v2, s[8:11], s17 offen offset:2048 lds
    buffer_load_dwordx4 v2, s[8:11], s17 offen offset:3072 lds
    s_add_u32 s17, s17, 4096
    s_mov_b32 m0, s19
    s_add_u32 s19, s19, 4096
    buffer_load_dwordx4 v2, s[8:11], s17 offen offset:0 lds
    s_add_u32 s17, s17, 4096
    s_mul_i32 s15, s24, 5120
    s_add_u32 s15, s15, 45056
    s_add_u32 s17, s15, s18
    s_add_u32 s17, s17, 4194304
    s_add_u32 s19, s15, 65536
    s_mov_b32 m0, s19
    s_add_u32 s19, s19, 4096
    buffer_load_dwordx4 v2, s[8:11], s17 offen offset:0 lds
    buffer_load_dwordx4 v2, s[8:11], s17 offen offset:1024 lds
    buffer_load_dwordx4 v2, s[8:11], s17 offen offset:2048 lds
    buffer_load_dwordx4 v2, s[8:11], s17 offen offset:3072 lds
    s_add_u32 s17, s17, 4096
    s_mov_b32 m0, s19
    s_add_u32 s19, s19, 4096
    buffer_load_dwordx4 v2, s[8:11], s17 offen offset:0 lds
    s_add_u32 s17, s17, 4096
    s_branch attn_kernel_nobar
attn_kernel_it1:
    s_waitcnt vmcnt(12)
    s_mov_b64 exec, 1
    ds_add_u32 v232, v233 offset:12
    s_mov_b64 exec, -1
    s_branch attn_kernel_nobar
attn_kernel_polla:
    ds_read_b32 v234, v237
    s_waitcnt lgkmcnt(0)
    v_readfirstlane_b32 s38, v234
    s_cmp_ge_u32 s38, 4
    s_cbranch_scc1 attn_kernel_nobar
    s_sleep 2
    s_branch attn_kernel_polla
attn_kernel_nobar:
    s_cmp_eq_u32 s22, 7
    s_cselect_b32 s35, s40, s35
    s_cselect_b32 s36, s41, s36
    s_cselect_b32 s34, s42, s34
    s_cmp_eq_u32 s22, 3
    s_cbranch_scc0 attn_kernel_p1
    s_setprio 2
attn_kernel_p1:
    s_cmp_eq_u32 s22, 6
    s_cbranch_scc0 attn_kernel_p2
    s_setprio 1
attn_kernel_p2:
    s_cmp_eq_u32 s22, 7
    s_cbranch_scc0 attn_kernel_p3
    s_setprio 0
attn_kernel_p3:
    s_waitcnt lgkmcnt(0)
    v_mfma_f32_32x32x16_bf16 v[64:79], v[128:131], v[12:15], v[32:47]
    v_exp_f32 v48, v48
    v_exp_f32 v49, v49
    v_exp_f32 v50, v50
    v_exp_f32 v51, v51
    v_cvt_pk_bf16_f32 v80, v48, v49
    v_mfma_f32_32x32x16_bf16 v[112:127], v[148:151], v[92:95], v[112:127]
    v_exp_f32 v52, v52
    ds_read_b128 v[128:131], v3 offset:2048
    s_mov_b64 exec, s[20:21]
    ds_read_b128 v[144:147], v4 offset:1024
    ds_read_b128 v[148:151], v4 offset:1536
    s_mov_b64 exec, -1
    v_exp_f32 v53, v53
    v_cvt_pk_bf16_f32 v81, v50, v51
    v_exp_f32 v54, v54
    v_exp_f32 v55, v55
    v_cvt_pk_bf16_f32 v82, v52, v53
    s_waitcnt vmcnt(9)
    v_mfma_f32_32x32x16_bf16 v[152:167], v[188:191], v[184:187], v[152:167]
    buffer_load_dwordx4 v[188:191], v2, s[28:31], s35 offen offset:0
    v_exp_f32 v56, v56
    v_exp_f32 v57, v57
    v_cvt_pk_bf16_f32 v83, v54, v55
    v_exp_f32 v58, v58
    v_exp_f32 v59, v59
    v_cvt_pk_bf16_f32 v84, v56, v57
    v_mfma_f32_32x32x16_bf16 v[96:111], v[136:139], v[80:83], v[96:111]
    v_exp_f32 v60, v60
    v_exp_f32 v61, v61
    v_cvt_pk_bf16_f32 v85, v58, v59
    v_exp_f32 v62, v62
    v_exp_f32 v63, v63
    v_cvt_pk_bf16_f32 v86, v60, v61
    v_cvt_pk_bf16_f32 v87, v62, v63
    v_mfma_f32_32x32x16_bf16 v[48:63], v[132:135], v[8:11], v[16:31]
    v_exp_f32 v64, v64
    v_exp_f32 v65, v65
    v_exp_f32 v66, v66
    v_exp_f32 v67, v67
    v_cvt_pk_bf16_f32 v88, v64, v65
    v_mfma_f32_32x32x16_bf16 v[96:111], v[140:143], v[84:87], v[96:111]
    v_exp_f32 v68, v68
    v_exp_f32 v69, v69
    v_cvt_pk_bf16_f32 v89, v66, v67
    v_exp_f32 v70, v70
    v_exp_f32 v71, v71
    v_cvt_pk_bf16_f32 v90, v68, v69
    v_mfma_f32_32x32x16_bf16 v[168:183], v[192:195], v[184:187], v[168:183]
    buffer_load_dwordx4 v[192:195], v2, s[28:31], s36 offen offset:0
    buffer_load_dwordx4 v[184:187], v2, s[28:31], s34 offen offset:0
    v_exp_f32 v72, v72
    v_exp_f32 v73, v73
    v_cvt_pk_bf16_f32 v91, v70, v71
    v_exp_f32 v74, v74
    v_exp_f32 v75, v75
    v_mfma_f32_32x32x16_bf16 v[112:127], v[136:139], v[88:91], v[112:127]
    v_cvt_pk_bf16_f32 v92, v72, v73
    v_exp_f32 v76, v76
    v_exp_f32 v77, v77
    v_cvt_pk_bf16_f32 v93, v74, v75
    v_exp_f32 v78, v78
    v_exp_f32 v79, v79
    v_cvt_pk_bf16_f32 v94, v76, v77
    v_cvt_pk_bf16_f32 v95, v78, v79
    s_waitcnt lgkmcnt(0)
    v_mfma_f32_32x32x16_bf16 v[64:79], v[132:135], v[12:15], v[32:47]
    v_exp_f32 v48, v48
    v_exp_f32 v49, v49
    v_exp_f32 v50, v50
    v_exp_f32 v51, v51
    v_cvt_pk_bf16_f32 v80, v48, v49
    v_mfma_f32_32x32x16_bf16 v[112:127], v[140:143], v[92:95], v[112:127]
    v_exp_f32 v52, v52
    ds_read_b128 v[132:135], v3 offset:3072
    s_mov_b64 exec, s[20:21]
    ds_read_b128 v[136:139], v4 offset:2048
    ds_read_b128 v[140:143], v4 offset:2560
    s_mov_b64 exec, -1
    v_exp_f32 v53, v53
    v_cvt_pk_bf16_f32 v81, v50, v51
    v_exp_f32 v54, v54
    v_exp_f32 v55, v55
    v_cvt_pk_bf16_f32 v82, v52, v53
    s_waitcnt vmcnt(9)
    v_mfma_f32_32x32x16_bf16 v[152:167], v[200:203], v[196:199], v[152:167]
    buffer_load_dwordx4 v[200:203], v2, s[28:31], s35 offen offset:1024
    v_exp_f32 v56, v56
    v_exp_f32 v57, v57
    v_cvt_pk_bf16_f32 v83, v54, v55
    v_exp_f32 v58, v58
    v_exp_f32 v59, v59
    v_cvt_pk_bf16_f32 v84, v56, v57
    v_mfma_f32_32x32x16_bf16 v[96:111], v[144:147], v[80:83], v[96:111]
    v_exp_f32 v60, v60
    v_exp_f32 v61, v61
    v_cvt_pk_bf16_f32 v85, v58, v59
    v_exp_f32 v62, v62
    v_exp_f32 v63, v63
    v_cvt_pk_bf16_f32 v86, v60, v61
    v_cvt_pk_bf16_f32 v87, v62, v63
    v_mfma_f32_32x32x16_bf16 v[48:63], v[128:131], v[8:11], v[16:31]
    v_exp_f32 v64, v64
    v_exp_f32 v65, v65
    v_exp_f32 v66, v66
    v_exp_f32 v67, v67
    v_cvt_pk_bf16_f32 v88, v64, v65
    v_mfma_f32_32x32x16_bf16 v[96:111], v[148:151], v[84:87], v[96:111]
    v_exp_f32 v68, v68
    v_exp_f32 v69, v69
    v_cvt_pk_bf16_f32 v89, v66, v67
    v_exp_f32 v70, v70
    v_exp_f32 v71, v71
    v_cvt_pk_bf16_f32 v90, v68, v69
    v_mfma_f32_32x32x16_bf16 v[168:183], v[204:207], v[196:199], v[168:183]
    buffer_load_dwordx4 v[204:207], v2, s[28:31], s36 offen offset:1024
    buffer_load_dwordx4 v[196:199], v2, s[28:31], s34 offen offset:1024
    v_exp_f32 v72, v72
    v_exp_f32 v73, v73
    v_cvt_pk_bf16_f32 v91, v70, v71
    v_exp_f32 v74, v74
    v_exp_f32 v75, v75
    v_mfma_f32_32x32x16_bf16 v[112:127], v[144:147], v[88:91], v[112:127]
    v_cvt_pk_bf16_f32 v92, v72, v73
    v_exp_f32 v76, v76
    v_exp_f32 v77, v77
    v_cvt_pk_bf16_f32 v93, v74, v75
    v_exp_f32 v78, v78
    v_exp_f32 v79, v79
    v_cvt_pk_bf16_f32 v94, v76, v77
    v_cvt_pk_bf16_f32 v95, v78, v79
    s_waitcnt lgkmcnt(0)
    v_mfma_f32_32x32x16_bf16 v[64:79], v[128:131], v[12:15], v[32:47]
    v_exp_f32 v48, v48
    v_exp_f32 v49, v49
    v_exp_f32 v50, v50
    v_exp_f32 v51, v51
    v_cvt_pk_bf16_f32 v80, v48, v49
    v_mfma_f32_32x32x16_bf16 v[112:127], v[148:151], v[92:95], v[112:127]
    v_exp_f32 v52, v52
    ds_read_b128 v[128:131], v3 offset:4096
    s_mov_b64 exec, s[20:21]
    ds_read_b128 v[144:147], v4 offset:3072
    ds_read_b128 v[148:151], v4 offset:3584
    s_mov_b64 exec, -1
    v_exp_f32 v53, v53
    v_cvt_pk_bf16_f32 v81, v50, v51
    v_exp_f32 v54, v54
    v_exp_f32 v55, v55
    v_cvt_pk_bf16_f32 v82, v52, v53
    s_waitcnt vmcnt(9)
    v_mfma_f32_32x32x16_bf16 v[152:167], v[212:215], v[208:211], v[152:167]
    buffer_load_dwordx4 v[212:215], v2, s[28:31], s35 offen offset:2048
    v_exp_f32 v56, v56
    v_exp_f32 v57, v57
    v_cvt_pk_bf16_f32 v83, v54, v55
    v_exp_f32 v58, v58
    v_exp_f32 v59, v59
    v_cvt_pk_bf16_f32 v84, v56, v57
    v_mfma_f32_32x32x16_bf16 v[96:111], v[136:139], v[80:83], v[96:111]
    v_exp_f32 v60, v60
    v_exp_f32 v61, v61
    v_cvt_pk_bf16_f32 v85, v58, v59
    v_exp_f32 v62, v62
    v_exp_f32 v63, v63
    v_cvt_pk_bf16_f32 v86, v60, v61
    v_cvt_pk_bf16_f32 v87, v62, v63
    v_mfma_f32_32x32x16_bf16 v[48:63], v[132:135], v[8:11], v[16:31]
    v_exp_f32 v64, v64
    v_exp_f32 v65, v65
    v_exp_f32 v66, v66
    v_exp_f32 v67, v67
    v_cvt_pk_bf16_f32 v88, v64, v65
    v_mfma_f32_32x32x16_bf16 v[96:111], v[140:143], v[84:87], v[96:111]
    v_exp_f32 v68, v68
    v_exp_f32 v69, v69
    v_cvt_pk_bf16_f32 v89, v66, v67
    v_exp_f32 v70, v70
    v_exp_f32 v71, v71
    v_cvt_pk_bf16_f32 v90, v68, v69
    v_mfma_f32_32x32x16_bf16 v[168:183], v[216:219], v[208:211], v[168:183]
    buffer_load_dwordx4 v[216:219], v2, s[28:31], s36 offen offset:2048
    buffer_load_dwordx4 v[208:211], v2, s[28:31], s34 offen offset:2048
    v_exp_f32 v72, v72
    v_exp_f32 v73, v73
    v_cvt_pk_bf16_f32 v91, v70, v71
    v_exp_f32 v74, v74
    v_exp_f32 v75, v75
    v_mfma_f32_32x32x16_bf16 v[112:127], v[136:139], v[88:91], v[112:127]
    v_cvt_pk_bf16_f32 v92, v72, v73
    v_exp_f32 v76, v76
    v_exp_f32 v77, v77
    v_cvt_pk_bf16_f32 v93, v74, v75
    v_exp_f32 v78, v78
    v_exp_f32 v79, v79
    v_cvt_pk_bf16_f32 v94, v76, v77
    v_cvt_pk_bf16_f32 v95, v78, v79
    s_waitcnt lgkmcnt(0)
    v_mfma_f32_32x32x16_bf16 v[64:79], v[132:135], v[12:15], v[32:47]
    v_exp_f32 v48, v48
    v_exp_f32 v49, v49
    v_exp_f32 v50, v50
    v_exp_f32 v51, v51
    v_cvt_pk_bf16_f32 v80, v48, v49
    v_mfma_f32_32x32x16_bf16 v[112:127], v[140:143], v[92:95], v[112:127]
    v_exp_f32 v52, v52
    ds_read_b128 v[132:135], v3 offset:5120
    s_mov_b64 exec, s[20:21]
    ds_read_b128 v[136:139], v4 offset:4096
    ds_read_b128 v[140:143], v4 offset:4608
    s_mov_b64 exec, -1
    v_exp_f32 v53, v53
    v_cvt_pk_bf16_f32 v81, v50, v51
    v_exp_f32 v54, v54
    v_exp_f32 v55, v55
    v_cvt_pk_bf16_f32 v82, v52, v53
    s_waitcnt vmcnt(9)
    v_mfma_f32_32x32x16_bf16 v[152:167], v[224:227], v[220:223], v[152:167]
    buffer_load_dwordx4 v[224:227], v2, s[28:31], s35 offen offset:3072
    v_exp_f32 v56, v56
    v_exp_f32 v57, v57
    v_cvt_pk_bf16_f32 v83, v54, v55
    v_exp_f32 v58, v58
    v_exp_f32 v59, v59
    v_cvt_pk_bf16_f32 v84, v56, v57
    v_mfma_f32_32x32x16_bf16 v[96:111], v[144:147], v[80:83], v[96:111]
    v_exp_f32 v60, v60
    v_exp_f32 v61, v61
    v_cvt_pk_bf16_f32 v85, v58, v59
    v_exp_f32 v62, v62
    v_exp_f32 v63, v63
    v_cvt_pk_bf16_f32 v86, v60, v61
    v_cvt_pk_bf16_f32 v87, v62, v63
    v_mfma_f32_32x32x16_bf16 v[48:63], v[128:131], v[8:11], v[16:31]
    v_exp_f32 v64, v64
    v_exp_f32 v65, v65
    v_exp_f32 v66, v66
    v_exp_f32 v67, v67
    v_cvt_pk_bf16_f32 v88, v64, v65
    v_mfma_f32_32x32x16_bf16 v[96:111], v[148:151], v[84:87], v[96:111]
    v_exp_f32 v68, v68
    v_exp_f32 v69, v69
    v_cvt_pk_bf16_f32 v89, v66, v67
    v_exp_f32 v70, v70
    v_exp_f32 v71, v71
    v_cvt_pk_bf16_f32 v90, v68, v69
    v_mfma_f32_32x32x16_bf16 v[168:183], v[228:231], v[220:223], v[168:183]
    buffer_load_dwordx4 v[228:231], v2, s[28:31], s36 offen offset:3072
    buffer_load_dwordx4 v[220:223], v2, s[28:31], s34 offen offset:3072
    v_exp_f32 v72, v72
    v_exp_f32 v73, v73
    v_cvt_pk_bf16_f32 v91, v70, v71
    v_exp_f32 v74, v74
    v_exp_f32 v75, v75
    v_mfma_f32_32x32x16_bf16 v[112:127], v[144:147], v[88:91], v[112:127]
    v_cvt_pk_bf16_f32 v92, v72, v73
    v_exp_f32 v76, v76
    v_exp_f32 v77, v77
    v_cvt_pk_bf16_f32 v93, v74, v75
    v_exp_f32 v78, v78
    v_exp_f32 v79, v79
    v_cvt_pk_bf16_f32 v94, v76, v77
    v_cvt_pk_bf16_f32 v95, v78, v79
    v_add_u32 v3, 0x1000, v3
    v_add_u32 v4, 0x1000, v4
    s_add_u32 s34, s34, 4096
    s_add_u32 s35, s35, 4096
    s_add_u32 s36, s36, 4096
    s_add_u32 s22, s22, 1
    s_cmp_lt_u32 s22, 8
    s_cbranch_scc1 attn_kernel_loop
    s_waitcnt lgkmcnt(0)
    v_mfma_f32_32x32x16_bf16 v[112:127], v[148:151], v[92:95], v[112:127]
    s_setprio 0
    s_nop 15
    s_mov_b32 s23, 0x5f800000
    v_cmp_gt_f32 vcc, s23, v104
    v_cmp_gt_f32 s[60:61], s23, v120
    s_nop 1
    s_and_b64 vcc, vcc, s[60:61]
    s_cmp_eq_u64 vcc, exec
    s_cbranch_scc0 attn_kernel_fallback
attn_kernel_fin:
    buffer_load_dwordx4 v[128:131], v2, s[8:11], s43 offen offset:0
    buffer_load_dwordx4 v[132:135], v2, s[8:11], s43 offen offset:1024
    buffer_load_dwordx4 v[136:139], v2, s[8:11], s43 offen offset:2048
    buffer_load_dwordx4 v[140:143], v2, s[8:11], s43 offen offset:3072
    s_mov_b32 s52, s6
    s_and_b32 s53, s7, 0xffff
    s_mov_b32 s54, 2097152
    s_mov_b32 s55, 0x20000
    s_mov_b32 s56, s44
    s_and_b32 s57, s45, 0xffff
    s_mov_b32 s58, 2097152
    s_mov_b32 s59, 0x20000
    v_lshrrev_b32 v5, 3, v1
    v_lshlrev_b32 v5, 10, v5
    v_and_b32 v6, 7, v1
    v_lshlrev_b32 v6, 4, v6
    v_add_u32 v236, v5, v6
    s_lshl_b32 s49, s13, 16
    s_lshl_b32 s50, s12, 13
    s_add_u32 s49, s49, s50
    s_lshl_b32 s50, s33, 6
    s_add_u32 s49, s49, s50
    buffer_load_dwordx4 v[240:243], v236, s[52:55], s49 offen
    s_barrier
    s_lshl_b32 s15, s12, 11
    v_add_u32 v5, s15, v2
    s_xor_b32 s16, s12, 4
    s_lshl_b32 s16, s16, 11
    v_add_u32 v6, s16, v2
    s_cmp_eq_u32 s25, 0
    s_cbranch_scc0 attn_kernel_x1
    ds_write_b128 v5, v[112:115]
    ds_write_b128 v5, v[116:119] offset:1024
    v_mov_b32 v121, v32
    v_lshrrev_b32 v7, 1, v2
    s_lshl_b32 s15, s12, 9
    s_add_u32 s15, s15, 16384
    v_add_u32 v7, s15, v7
    ds_write_b64 v7, v[120:121]
    s_waitcnt lgkmcnt(0)
    s_barrier
    ds_read_b128 v[48:51], v6
    ds_read_b128 v[52:55], v6 offset:1024
    v_lshrrev_b32 v7, 1, v2
    s_xor_b32 s15, s12, 4
    s_lshl_b32 s15, s15, 9
    s_add_u32 s15, s15, 16384
    v_add_u32 v7, s15, v7
    ds_read_b64 v[64:65], v7
    s_waitcnt lgkmcnt(0)
    v_sub_f32 v5, v16, v65
    v_max_f32 v6, 0, v5
    v_sub_f32 v7, 0, v6
    v_exp_f32 v7, v7
    v_sub_f32 v5, v5, v6
    v_exp_f32 v5, v5
    s_nop 0
    v_mul_f32 v6, v104, v7
    v_fma_f32 v6, v64, v5, v6
    v_rcp_f32 v6, v6
    s_nop 0
    v_mul_f32 v7, v7, v6
    v_mul_f32 v5, v5, v6
    v_mul_f32 v96, v96, v7
    v_fma_f32 v96, v48, v5, v96
    v_mul_f32 v97, v97, v7
    v_fma_f32 v97, v49, v5, v97
    v_mul_f32 v98, v98, v7
    v_fma_f32 v98, v50, v5, v98
    v_mul_f32 v99, v99, v7
    v_fma_f32 v99, v51, v5, v99
    v_mul_f32 v100, v100, v7
    v_fma_f32 v100, v52, v5, v100
    v_mul_f32 v101, v101, v7
    v_fma_f32 v101, v53, v5, v101
    v_mul_f32 v102, v102, v7
    v_fma_f32 v102, v54, v5, v102
    v_mul_f32 v103, v103, v7
    v_fma_f32 v103, v55, v5, v103
    v_cvt_pk_bf16_f32 v80, v96, v97
    v_cvt_pk_bf16_f32 v81, v98, v99
    v_cvt_pk_bf16_f32 v82, v100, v101
    v_cvt_pk_bf16_f32 v83, v102, v103
    s_add_u32 s15, s14, 0
    s_lshl_b32 s15, s15, 5
    s_add_u32 s15, s15, s13
    s_lshl_b32 s15, s15, 10
    s_add_u32 s15, s15, 6291456
    buffer_store_dwordx4 v[80:83], v2, s[8:11], s15 offen sc1
    s_branch attn_kernel_st
attn_kernel_x1:
    ds_write_b128 v5, v[96:99]
    ds_write_b128 v5, v[100:103] offset:1024
    v_mov_b32 v105, v16
    v_lshrrev_b32 v7, 1, v2
    s_lshl_b32 s15, s12, 9
    s_add_u32 s15, s15, 16384
    v_add_u32 v7, s15, v7
    ds_write_b64 v7, v[104:105]
    s_waitcnt lgkmcnt(0)
    s_barrier
    ds_read_b128 v[48:51], v6
    ds_read_b128 v[52:55], v6 offset:1024
    v_lshrrev_b32 v7, 1, v2
    s_xor_b32 s15, s12, 4
    s_lshl_b32 s15, s15, 9
    s_add_u32 s15, s15, 16384
    v_add_u32 v7, s15, v7
    ds_read_b64 v[64:65], v7
    s_waitcnt lgkmcnt(0)
    v_sub_f32 v5, v32, v65
    v_max_f32 v6, 0, v5
    v_sub_f32 v7, 0, v6
    v_exp_f32 v7, v7
    v_sub_f32 v5, v5, v6
    v_exp_f32 v5, v5
    s_nop 0
    v_mul_f32 v6, v120, v7
    v_fma_f32 v6, v64, v5, v6
    v_rcp_f32 v6, v6
    s_nop 0
    v_mul_f32 v7, v7, v6
    v_mul_f32 v5, v5, v6
    v_mul_f32 v112, v112, v7
    v_fma_f32 v112, v48, v5, v112
    v_mul_f32 v113, v113, v7
    v_fma_f32 v113, v49, v5, v113
    v_mul_f32 v114, v114, v7
    v_fma_f32 v114, v50, v5, v114
    v_mul_f32 v115, v115, v7
    v_fma_f32 v115, v51, v5, v115
    v_mul_f32 v116, v116, v7
    v_fma_f32 v116, v52, v5, v116
    v_mul_f32 v117, v117, v7
    v_fma_f32 v117, v53, v5, v117
    v_mul_f32 v118, v118, v7
    v_fma_f32 v118, v54, v5, v118
    v_mul_f32 v119, v119, v7
    v_fma_f32 v119, v55, v5, v119
    v_cvt_pk_bf16_f32 v80, v112, v113
    v_cvt_pk_bf16_f32 v81, v114, v115
    v_cvt_pk_bf16_f32 v82, v116, v117
    v_cvt_pk_bf16_f32 v83, v118, v119
    s_add_u32 s15, s14, 1
    s_lshl_b32 s15, s15, 5
    s_add_u32 s15, s15, s13
    s_lshl_b32 s15, s15, 10
    s_add_u32 s15, s15, 6291456
    buffer_store_dwordx4 v[80:83], v2, s[8:11], s15 offen sc1
attn_kernel_st:
    s_lshl_b32 s15, s27, 15
    s_lshl_b32 s16, s48, 13
    s_add_u32 s15, s15, s16
    s_add_u32 s15, s15, 6291456
    s_add_u32 s16, s15, 4096
    s_mov_b32 s17, 0
attn_kernel_spin:
    buffer_load_dwordx4 v[48:51], v2, s[8:11], s15 offen offset:0 sc1
    buffer_load_dwordx4 v[52:55], v2, s[8:11], s15 offen offset:1024 sc1
    buffer_load_dwordx4 v[56:59], v2, s[8:11], s15 offen offset:2048 sc1
    buffer_load_dwordx4 v[60:63], v2, s[8:11], s15 offen offset:3072 sc1
    buffer_load_dwordx4 v[64:67], v2, s[8:11], s16 offen offset:0 sc1
    buffer_load_dwordx4 v[68:71], v2, s[8:11], s16 offen offset:1024 sc1
    buffer_load_dwordx4 v[72:75], v2, s[8:11], s16 offen offset:2048 sc1
    buffer_load_dwordx4 v[76:79], v2, s[8:11], s16 offen offset:3072 sc1
    s_add_u32 s17, s17, 1
    s_waitcnt vmcnt(7)
    v_max3_u32 v5, v48, v49, v50
    v_max_u32 v5, v5, v51
    s_waitcnt vmcnt(6)
    v_max3_u32 v5, v5, v52, v53
    v_max3_u32 v5, v5, v54, v55
    s_waitcnt vmcnt(5)
    v_max3_u32 v5, v5, v56, v57
    v_max3_u32 v5, v5, v58, v59
    s_waitcnt vmcnt(4)
    v_max3_u32 v5, v5, v60, v61
    v_max3_u32 v5, v5, v62, v63
    s_waitcnt vmcnt(3)
    v_max3_u32 v5, v5, v64, v65
    v_max3_u32 v5, v5, v66, v67
    s_waitcnt vmcnt(2)
    v_max3_u32 v5, v5, v68, v69
    v_max3_u32 v5, v5, v70, v71
    s_waitcnt vmcnt(1)
    v_max3_u32 v5, v5, v72, v73
    v_max3_u32 v5, v5, v74, v75
    s_waitcnt vmcnt(0)
    v_max3_u32 v5, v5, v76, v77
    v_max3_u32 v5, v5, v78, v79
    v_cmp_eq_u32 vcc, -1, v5
    s_cmp_lt_u32 s17, 0x20000
    s_cbranch_scc0 attn_kernel_nw
    s_cbranch_vccz attn_kernel_nw
    s_sleep 4
    s_branch attn_kernel_spin
attn_kernel_nw:
    v_mfma_f32_32x32x16_bf16 v[152:167], v[188:191], v[48:51], v[152:167]
    v_mfma_f32_32x32x16_bf16 v[168:183], v[192:195], v[48:51], v[168:183]
    v_mfma_f32_32x32x16_bf16 v[152:167], v[200:203], v[52:55], v[152:167]
    v_mfma_f32_32x32x16_bf16 v[168:183], v[204:207], v[52:55], v[168:183]
    v_mfma_f32_32x32x16_bf16 v[152:167], v[212:215], v[56:59], v[152:167]
    v_mfma_f32_32x32x16_bf16 v[168:183], v[216:219], v[56:59], v[168:183]
    v_mfma_f32_32x32x16_bf16 v[152:167], v[224:227], v[60:63], v[152:167]
    v_mfma_f32_32x32x16_bf16 v[168:183], v[228:231], v[60:63], v[168:183]
    v_mfma_f32_32x32x16_bf16 v[152:167], v[184:187], v[64:67], v[152:167]
    v_mfma_f32_32x32x16_bf16 v[168:183], v[128:131], v[64:67], v[168:183]
    v_mfma_f32_32x32x16_bf16 v[152:167], v[196:199], v[68:71], v[152:167]
    v_mfma_f32_32x32x16_bf16 v[168:183], v[132:135], v[68:71], v[168:183]
    v_mfma_f32_32x32x16_bf16 v[152:167], v[208:211], v[72:75], v[152:167]
    v_mfma_f32_32x32x16_bf16 v[168:183], v[136:139], v[72:75], v[168:183]
    v_mfma_f32_32x32x16_bf16 v[152:167], v[220:223], v[76:79], v[152:167]
    v_mfma_f32_32x32x16_bf16 v[168:183], v[140:143], v[76:79], v[168:183]
    s_and_b32 s15, s12, 1
    s_lshl_b32 s15, s15, 2
    s_add_u32 s15, s15, s48
    s_mul_i32 s15, s15, 8448
    s_add_u32 s15, s15, 32768
    v_add_u32 v5, s15, v2
    s_lshr_b32 s15, s12, 2
    s_mul_i32 s15, s15, 33792
    s_and_b32 s16, s12, 3
    s_lshl_b32 s16, s16, 7
    s_add_u32 s15, s15, s16
    s_add_u32 s15, s15, 32768
    v_lshrrev_b32 v6, 3, v1
    v_lshlrev_b32 v6, 4, v6
    v_and_b32 v7, 3, v1
    v_mul_u32_u24 v7, 1056, v7
    v_add_u32 v6, v6, v7
    v_bfe_u32 v7, v1, 2, 1
    v_mul_u32_u24 v7, 4224, v7
    v_add_u32 v6, v6, v7
    v_add_u32 v6, s15, v6
    s_nop 7
    ds_write_b128 v5, v[152:155] offset:0
    ds_write_b128 v5, v[156:159] offset:1056
    ds_write_b128 v5, v[160:163] offset:2112
    ds_write_b128 v5, v[164:167] offset:3168
    ds_write_b128 v5, v[168:171] offset:4224
    ds_write_b128 v5, v[172:175] offset:5280
    ds_write_b128 v5, v[176:179] offset:6336
    ds_write_b128 v5, v[180:183] offset:7392
    s_waitcnt lgkmcnt(0)
    s_barrier
    ds_read_b128 v[48:51], v6 offset:0
    ds_read_b128 v[52:55], v6 offset:512
    ds_read_b128 v[56:59], v6 offset:8448
    ds_read_b128 v[60:63], v6 offset:8960
    ds_read_b128 v[64:67], v6 offset:16896
    ds_read_b128 v[68:71], v6 offset:17408
    ds_read_b128 v[72:75], v6 offset:25344
    ds_read_b128 v[76:79], v6 offset:25856
    s_waitcnt lgkmcnt(4)
    v_add_f32 v48, v48, v56
    v_add_f32 v49, v49, v57
    v_add_f32 v50, v50, v58
    v_add_f32 v51, v51, v59
    v_add_f32 v52, v52, v60
    v_add_f32 v53, v53, v61
    v_add_f32 v54, v54, v62
    v_add_f32 v55, v55, v63
    s_waitcnt lgkmcnt(0)
    v_add_f32 v64, v64, v72
    v_add_f32 v65, v65, v73
    v_add_f32 v66, v66, v74
    v_add_f32 v67, v67, v75
    v_add_f32 v68, v68, v76
    v_add_f32 v69, v69, v77
    v_add_f32 v70, v70, v78
    v_add_f32 v71, v71, v79
    v_add_f32 v48, v48, v64
    v_add_f32 v49, v49, v65
    v_add_f32 v50, v50, v66
    v_add_f32 v51, v51, v67
    v_add_f32 v52, v52, v68
    v_add_f32 v53, v53, v69
    v_add_f32 v54, v54, v70
    v_add_f32 v55, v55, v71
    v_lshlrev_b32 v6, 16, v240
    v_and_b32 v7, 0xffff0000, v240
    v_add_f32 v6, v6, v48
    v_add_f32 v7, v7, v49
    v_cvt_pk_bf16_f32 v240, v6, v7
    v_lshlrev_b32 v6, 16, v241
    v_and_b32 v7, 0xffff0000, v241
    v_add_f32 v6, v6, v50
    v_add_f32 v7, v7, v51
    v_cvt_pk_bf16_f32 v241, v6, v7
    v_lshlrev_b32 v6, 16, v242
    v_and_b32 v7, 0xffff0000, v242
    v_add_f32 v6, v6, v52
    v_add_f32 v7, v7, v53
    v_cvt_pk_bf16_f32 v242, v6, v7
    v_lshlrev_b32 v6, 16, v243
    v_and_b32 v7, 0xffff0000, v243
    v_add_f32 v6, v6, v54
    v_add_f32 v7, v7, v55
    v_cvt_pk_bf16_f32 v243, v6, v7
    buffer_store_dwordx4 v[240:243], v236, s[56:59], s49 offen sc1
attn_kernel_end:
    s_endpgm
attn_kernel_fallback:
    v_subrev_u32 v3, 0x8000, v3
    v_subrev_u32 v4, 0x8000, v4
    v_mov_b32 v242, v3
    v_mov_b32 v243, v4
    v_mov_b32 v3, v242
    v_mov_b32 v5, 0xff800000
    s_mov_b32 s22, 0
attn_kernel_fb1_0:
    ds_read_b128 v[128:131], v3
    s_waitcnt lgkmcnt(0)
    v_mfma_f32_32x32x16_bf16 v[48:63], v[128:131], v[8:11], 0
    v_add_u32 v3, 0x400, v3
    s_nop 15
    s_nop 3
    v_max3_f32 v5, v5, v48, v49
    v_max3_f32 v5, v5, v50, v51
    v_max3_f32 v5, v5, v52, v53
    v_max3_f32 v5, v5, v54, v55
    v_max3_f32 v5, v5, v56, v57
    v_max3_f32 v5, v5, v58, v59
    v_max3_f32 v5, v5, v60, v61
    v_max3_f32 v5, v5, v62, v63
    s_add_u32 s22, s22, 1
    s_cmp_lt_u32 s22, 32
    s_cbranch_scc1 attn_kernel_fb1_0
    s_nop 0
    v_mov_b32 v6, v5
    s_nop 1
    v_permlane32_swap_b32 v5, v6
    s_nop 1
    v_max_f32 v5, v5, v6
    v_sub_f32 v5, 0, v5
    v_mov_b32 v16, v5
    v_mov_b32 v17, v5
    v_mov_b32 v18, v5
    v_mov_b32 v19, v5
    v_mov_b32 v20, v5
    v_mov_b32 v21, v5
    v_mov_b32 v22, v5
    v_mov_b32 v23, v5
    v_mov_b32 v24, v5
    v_mov_b32 v25, v5
    v_mov_b32 v26, v5
    v_mov_b32 v27, v5
    v_mov_b32 v28, v5
    v_mov_b32 v29, v5
    v_mov_b32 v30, v5
    v_mov_b32 v31, v5
    v_mov_b32 v96, 0
    v_mov_b32 v97, 0
    v_mov_b32 v98, 0
    v_mov_b32 v99, 0
    v_mov_b32 v100, 0
    v_mov_b32 v101, 0
    v_mov_b32 v102, 0
    v_mov_b32 v103, 0
    v_mov_b32 v104, 0
    v_mov_b32 v105, 0
    v_mov_b32 v106, 0
    v_mov_b32 v107, 0
    v_mov_b32 v108, 0
    v_mov_b32 v109, 0
    v_mov_b32 v110, 0
    v_mov_b32 v111, 0
    v_mov_b32 v3, v242
    v_mov_b32 v4, v243
    s_mov_b32 s22, 0
attn_kernel_fb2_0:
    ds_read_b128 v[128:131], v3
    s_mov_b64 exec, s[20:21]
    ds_read_b128 v[136:139], v4
    ds_read_b128 v[140:143], v4 offset:512
    s_mov_b64 exec, -1
    s_waitcnt lgkmcnt(0)
    v_mfma_f32_32x32x16_bf16 v[48:63], v[128:131], v[8:11], v[16:31]
    v_add_u32 v3, 0x400, v3
    v_add_u32 v4, 0x400, v4
    s_nop 15
    s_nop 3
    v_exp_f32 v48, v48
    v_exp_f32 v49, v49
    v_exp_f32 v50, v50
    v_exp_f32 v51, v51
    v_exp_f32 v52, v52
    v_exp_f32 v53, v53
    v_exp_f32 v54, v54
    v_exp_f32 v55, v55
    v_exp_f32 v56, v56
    v_exp_f32 v57, v57
    v_exp_f32 v58, v58
    v_exp_f32 v59, v59
    v_exp_f32 v60, v60
    v_exp_f32 v61, v61
    v_exp_f32 v62, v62
    v_exp_f32 v63, v63
    s_nop 0
    v_cvt_pk_bf16_f32 v80, v48, v49
    v_cvt_pk_bf16_f32 v81, v50, v51
    v_cvt_pk_bf16_f32 v82, v52, v53
    v_cvt_pk_bf16_f32 v83, v54, v55
    v_cvt_pk_bf16_f32 v84, v56, v57
    v_cvt_pk_bf16_f32 v85, v58, v59
    v_cvt_pk_bf16_f32 v86, v60, v61
    v_cvt_pk_bf16_f32 v87, v62, v63
    s_nop 1
    v_mfma_f32_32x32x16_bf16 v[96:111], v[136:139], v[80:83], v[96:111]
    v_mfma_f32_32x32x16_bf16 v[96:111], v[140:143], v[84:87], v[96:111]
    s_add_u32 s22, s22, 1
    s_cmp_lt_u32 s22, 32
    s_cbranch_scc1 attn_kernel_fb2_0
    s_nop 15
    s_nop 3
    v_mov_b32 v3, v242
    v_mov_b32 v5, 0xff800000
    s_mov_b32 s22, 0
attn_kernel_fb1_1:
    ds_read_b128 v[128:131], v3
    s_waitcnt lgkmcnt(0)
    v_mfma_f32_32x32x16_bf16 v[64:79], v[128:131], v[12:15], 0
    v_add_u32 v3, 0x400, v3
    s_nop 15
    s_nop 3
    v_max3_f32 v5, v5, v64, v65
    v_max3_f32 v5, v5, v66, v67
    v_max3_f32 v5, v5, v68, v69
    v_max3_f32 v5, v5, v70, v71
    v_max3_f32 v5, v5, v72, v73
    v_max3_f32 v5, v5, v74, v75
    v_max3_f32 v5, v5, v76, v77
    v_max3_f32 v5, v5, v78, v79
    s_add_u32 s22, s22, 1
    s_cmp_lt_u32 s22, 32
    s_cbranch_scc1 attn_kernel_fb1_1
    s_nop 0
    v_mov_b32 v6, v5
    s_nop 1
    v_permlane32_swap_b32 v5, v6
    s_nop 1
    v_max_f32 v5, v5, v6
    v_sub_f32 v5, 0, v5
    v_mov_b32 v32, v5
    v_mov_b32 v33, v5
    v_mov_b32 v34, v5
    v_mov_b32 v35, v5
    v_mov_b32 v36, v5
    v_mov_b32 v37, v5
    v_mov_b32 v38, v5
    v_mov_b32 v39, v5
    v_mov_b32 v40, v5
    v_mov_b32 v41, v5
    v_mov_b32 v42, v5
    v_mov_b32 v43, v5
    v_mov_b32 v44, v5
    v_mov_b32 v45, v5
    v_mov_b32 v46, v5
    v_mov_b32 v47, v5
    v_mov_b32 v112, 0
    v_mov_b32 v113, 0
    v_mov_b32 v114, 0
    v_mov_b32 v115, 0
    v_mov_b32 v116, 0
    v_mov_b32 v117, 0
    v_mov_b32 v118, 0
    v_mov_b32 v119, 0
    v_mov_b32 v120, 0
    v_mov_b32 v121, 0
    v_mov_b32 v122, 0
    v_mov_b32 v123, 0
    v_mov_b32 v124, 0
    v_mov_b32 v125, 0
    v_mov_b32 v126, 0
    v_mov_b32 v127, 0
    v_mov_b32 v3, v242
    v_mov_b32 v4, v243
    s_mov_b32 s22, 0
attn_kernel_fb2_1:
    ds_read_b128 v[128:131], v3
    s_mov_b64 exec, s[20:21]
    ds_read_b128 v[136:139], v4
    ds_read_b128 v[140:143], v4 offset:512
    s_mov_b64 exec, -1
    s_waitcnt lgkmcnt(0)
    v_mfma_f32_32x32x16_bf16 v[64:79], v[128:131], v[12:15], v[32:47]
    v_add_u32 v3, 0x400, v3
    v_add_u32 v4, 0x400, v4
    s_nop 15
    s_nop 3
    v_exp_f32 v64, v64
    v_exp_f32 v65, v65
    v_exp_f32 v66, v66
    v_exp_f32 v67, v67
    v_exp_f32 v68, v68
    v_exp_f32 v69, v69
    v_exp_f32 v70, v70
    v_exp_f32 v71, v71
    v_exp_f32 v72, v72
    v_exp_f32 v73, v73
    v_exp_f32 v74, v74
    v_exp_f32 v75, v75
    v_exp_f32 v76, v76
    v_exp_f32 v77, v77
    v_exp_f32 v78, v78
    v_exp_f32 v79, v79
    s_nop 0
    v_cvt_pk_bf16_f32 v88, v64, v65
    v_cvt_pk_bf16_f32 v89, v66, v67
    v_cvt_pk_bf16_f32 v90, v68, v69
    v_cvt_pk_bf16_f32 v91, v70, v71
    v_cvt_pk_bf16_f32 v92, v72, v73
    v_cvt_pk_bf16_f32 v93, v74, v75
    v_cvt_pk_bf16_f32 v94, v76, v77
    v_cvt_pk_bf16_f32 v95, v78, v79
    s_nop 1
    v_mfma_f32_32x32x16_bf16 v[112:127], v[136:139], v[88:91], v[112:127]
    v_mfma_f32_32x32x16_bf16 v[112:127], v[140:143], v[92:95], v[112:127]
    s_add_u32 s22, s22, 1
    s_cmp_lt_u32 s22, 32
    s_cbranch_scc1 attn_kernel_fb2_1
    s_nop 15
    s_nop 3
    s_branch attn_kernel_fin
TEXT_END:
.section .rodata,"a"
.p2align 6
.amdhsa_kernel gemm1_kernel
  .amdhsa_next_free_vgpr 256
  .amdhsa_next_free_sgpr 100
  .amdhsa_accum_offset 256
  .amdhsa_group_segment_fixed_size 0
  .amdhsa_kernarg_size 80
  .amdhsa_user_sgpr_count 2
  .amdhsa_user_sgpr_kernarg_segment_ptr 1
  .amdhsa_system_sgpr_workgroup_id_x 1
  .amdhsa_float_denorm_mode_32 3
.end_amdhsa_kernel
.section .rodata,"a"
.p2align 6
.amdhsa_kernel attn_kernel
  .amdhsa_next_free_vgpr 248
  .amdhsa_next_free_sgpr 100
  .amdhsa_accum_offset 248
  .amdhsa_group_segment_fixed_size 0
  .amdhsa_kernarg_size 80
  .amdhsa_user_sgpr_count 2
  .amdhsa_user_sgpr_kernarg_segment_ptr 1
  .amdhsa_system_sgpr_workgroup_id_x 1
  .amdhsa_float_denorm_mode_32 3
.end_amdhsa_kernel
```
